```python
import torch

def _softmax(x, axis=-1):
    return torch.softmax(x, dim=axis)
def _gelu(x):
    return torch.nn.functional.gelu(x, approximate="tanh")
def _silu(x):
    return torch.nn.functional.silu(x)
def _sigmoid(x):
    return torch.sigmoid(x)
def _layernorm(x, axis=-1, eps=1e-5):
    m = x.mean(dim=axis, keepdim=True)
    v = x.var(dim=axis, keepdim=True, unbiased=False)
    return (x - m) / torch.sqrt(v + eps)
def _scatter_add(tgt, idx, src, axis=0):
    return tgt.clone().index_add_(axis, idx, src)
def _segment_sum(src, seg, n):
    out = torch.zeros((n,) + src.shape[1:], dtype=src.dtype)
    return out.index_add_(0, seg, src)
def _pad(x, pw):
    flat = tuple(v for pair in reversed(pw) for v in pair)
    return torch.nn.functional.pad(x, flat)

kernel_name = 'recurrent_scan__sliding_local_dilated__glu_gated_reglu__prompt'

def setup_inputs():

    _w = (lambda a: (lambda t: t.to(torch.bfloat16) if t.is_floating_point() else t)(torch.as_tensor(a)))
    def _A_setup():
        B, S, D = 1, 2048, 512
        return {
            "x": _w((lambda *s: torch.randn(*s, dtype=torch.bfloat16) * 0.05)(B, S, D)),
            "wqkv": _w((lambda *s: torch.randn(*s, dtype=torch.bfloat16) * 0.2)(D, 3 * D)),
            "wo": _w((lambda *s: torch.randn(*s, dtype=torch.bfloat16) * 0.2)(D, D)),
        }
    _A_in = _A_setup()

    def _B_setup():
        B, S, D, F = 1, 2048, 512, 1792
        return {
            "x": _w((lambda *s: torch.randn(*s, dtype=torch.bfloat16) * 0.05)(B, S, D)),
            "W_gate": _w((lambda *s: torch.randn(*s, dtype=torch.bfloat16) * 0.1)(D, F) * (2.0 / D) ** 0.5),
            "W_up": _w((lambda *s: torch.randn(*s, dtype=torch.bfloat16) * 0.1)(D, F) * (2.0 / D) ** 0.5),
            "W_down": _w((lambda *s: torch.randn(*s, dtype=torch.bfloat16) * 0.1)(F, D) * (1.0 / F) ** 0.5),
        }
    _B_in = _B_setup()

    return {
        "A_x": _A_in["x"],
        "A_wqkv": _A_in["wqkv"],
        "A_wo": _A_in["wo"],
        "B_x": _B_in["x"],
        "B_W_gate": _B_in["W_gate"],
        "B_W_up": _B_in["W_up"],
        "B_W_down": _B_in["W_down"],
    }

def reference(A_x, A_wqkv, A_wo, B_x, B_W_gate, B_W_up, B_W_down):
    def _A_ref(x, wqkv, wo):
        B, S, D = x.shape
        H = 32; Dh = D // H
        W, dil = 8, 2
        qkv = (lambda x, *d: x.permute(*d))((x @ wqkv).reshape(B, S, 3, H, Dh), 2, 0, 3, 1, 4)
        q, k, v = qkv[0], qkv[1], qkv[2]
        scale = Dh ** -0.5
        pos = torch.arange(S)
        off = torch.arange(W) * dil
        idx = pos[:, None] - off[None, :]
        mask = idx >= 0
        idx_c = torch.where(mask, idx, 0).reshape(-1)
        kg = k[:, :, idx_c, :].reshape(B, H, S, W, Dh)
        vg = v[:, :, idx_c, :].reshape(B, H, S, W, Dh)
        logits = torch.einsum("bhsd,bhswd->bhsw", q, kg) * scale
        logits = torch.where(mask[None, None, :, :], logits, -1e9)
        attn = _softmax(logits, axis=-1)
        o = torch.einsum("bhsw,bhswd->bhsd", attn, vg)
        return (lambda x, *d: x.permute(*d))(o, 0, 2, 1, 3).reshape(B, S, D) @ wo

    def _B_ref(x, W_gate, W_up, W_down):
        gate = torch.einsum("bsd,df->bsf", x, W_gate)
        up = torch.einsum("bsd,df->bsf", x, W_up)
        gate = gate * (lambda x, dt: x.to(dt))(gate > 0, gate.dtype)
        h = gate * up
        return torch.einsum("bsf,fd->bsd", h, W_down)

    x = A_x
    xn = _layernorm(x, axis=-1)
    s = _A_ref(xn, A_wqkv, A_wo)
    g = _silu(_B_ref(xn, B_W_gate, B_W_up, B_W_down))
    return x + s * g
```

```asm
; @launch grid=(256,1,1) block=(512,1,1) lds=163840
.amdgcn_target "amdgcn-amd-amdhsa--gfx950"
.text
.globl recurrent_scan__sliding_local_dilated__glu_gated_reglu__prompt_kernel
.p2align 8
.type recurrent_scan__sliding_local_dilated__glu_gated_reglu__prompt_kernel,@function
recurrent_scan__sliding_local_dilated__glu_gated_reglu__prompt_kernel:
s_cmp_ge_u32 s2, 256
s_cbranch_scc1 END
s_load_dwordx16 s[4:19], s[0:1], 0
s_load_dwordx4 s[20:23], s[0:1], 64
v_and_b32 v1, 63, v0
v_lshrrev_b32 v2, 6, v0
s_nop 0
v_readfirstlane_b32 s60, v2
v_and_b32 v3, 15, v1
v_lshlrev_b32 v3, 2, v3
v_add_u32 v3, 147392, v3
v_mov_b32 v4, 0
ds_write_b32 v3, v4
s_and_b32 s61, s2, 7
s_lshr_b32 s62, s2, 3
s_lshr_b32 s63, s61, 2
s_lshl_b32 s63, s63, 3
s_and_b32 s67, s62, 7
s_add_u32 s63, s63, s67
s_and_b32 s64, s61, 3
s_lshl_b32 s64, s64, 2
s_lshr_b32 s67, s62, 3
s_add_u32 s64, s64, s67
s_lshr_b32 s66, s63, 2
s_and_b32 s65, s60, 3
s_and_b32 s66, s66, 2
s_cmp_ge_u32 s60, 4
s_cbranch_scc1 MSEL
v_lshrrev_b32 v40, 4, v1
v_lshrrev_b32 v41, 3, v1
v_and_b32 v42, 7, v1
v_xor_b32 v42, v42, v40
s_and_b32 s67, s60, 1
s_xor_b32 s67, s67, 1
s_lshl_b32 s68, s63, 7
s_lshl_b32 s69, s67, 6
s_add_u32 s69, s69, s68
v_add_u32 v43, s69, v41
v_lshlrev_b32 v43, 10, v43
v_lshl_add_u32 v16, v42, 4, v43
v_xor_b32 v43, 64, v16
v_add_u32 v17, 7168, v43
v_add_u32 v18, 14336, v16
v_add_u32 v19, 21504, v43
v_add_u32 v20, 32768, v16
v_add_u32 v21, 39936, v43
v_add_u32 v22, 47104, v16
v_add_u32 v23, 54272, v43
s_lshl_b32 s69, s67, 3
s_add_u32 s69, s69, s68
s_sub_u32 s69, s69, 16
s_lshl_b32 s70, s67, 6
v_add_u32 v43, s69, v41
v_max_i32 v43, 0, v43
v_lshlrev_b32 v43, 10, v43
v_lshl_add_u32 v43, v42, 4, v43
v_xor_b32 v24, s70, v43
s_add_u32 s68, s60, 1
s_lshr_b32 s68, s68, 1
s_lshl_b32 s50, s66, 8
s_lshl_b32 s69, s68, 7
s_add_u32 s50, s50, s69
s_and_b32 s50, s50, 1023
s_add_u32 s68, s68, 1
s_mul_i32 s55, s68, 63744
s_cmp_eq_u32 s68, 3
s_cselect_b32 s55, 0, s55
s_lshl_b32 s67, s67, 10
s_mov_b32 s59, s67
v_and_b32 v41, 15, v1
v_lshlrev_b32 v42, 1, v40
v_xor_b32 v41, v41, v42
v_mul_u32_u24 v42, 3584, v40
v_lshl_add_u32 v2, v41, 4, v42
v_add_u32 v3, 13312, v2
v_add_u32 v4, 26624, v2
v_add_u32 v5, 39936, v2
v_add_u32 v6, 57344, v2
v_add_u32 v7, 70656, v2
v_add_u32 v8, 83968, v2
v_add_u32 v9, 97280, v2
v_add_u32 v41, 0, v1
v_mul_u32_u24 v42, 171, v41
v_lshrrev_b32 v42, 11, v42
v_mul_u32_u24 v43, 12, v42
v_sub_u32 v43, v41, v43
v_mul_u32_u24 v42, 3072, v42
v_lshrrev_b32 v44, 2, v43
v_lshl_add_u32 v42, v44, 10, v42
v_and_b32 v43, 3, v43
v_lshl_add_u32 v10, v43, 4, v42
v_add_u32 v41, 64, v1
v_mul_u32_u24 v42, 171, v41
v_lshrrev_b32 v42, 11, v42
v_mul_u32_u24 v43, 12, v42
v_sub_u32 v43, v41, v43
v_mul_u32_u24 v42, 3072, v42
v_lshrrev_b32 v44, 2, v43
v_lshl_add_u32 v42, v44, 10, v42
v_and_b32 v43, 3, v43
v_lshl_add_u32 v11, v43, 4, v42
v_subrev_u32 v11, 1024, v11
v_add_u32 v41, 128, v1
v_mul_u32_u24 v42, 171, v41
v_lshrrev_b32 v42, 11, v42
v_mul_u32_u24 v43, 12, v42
v_sub_u32 v43, v41, v43
v_mul_u32_u24 v42, 3072, v42
v_lshrrev_b32 v44, 2, v43
v_lshl_add_u32 v42, v44, 10, v42
v_and_b32 v43, 3, v43
v_lshl_add_u32 v12, v43, 4, v42
v_subrev_u32 v12, 2048, v12
v_add_u32 v41, 192, v1
v_mul_u32_u24 v42, 171, v41
v_lshrrev_b32 v42, 11, v42
v_mul_u32_u24 v43, 12, v42
v_sub_u32 v43, v41, v43
v_mul_u32_u24 v42, 3072, v42
v_lshrrev_b32 v44, 2, v43
v_lshl_add_u32 v42, v44, 10, v42
v_and_b32 v43, 3, v43
v_lshl_add_u32 v13, v43, 4, v42
v_subrev_u32 v13, 3072, v13
v_add_u32 v41, 256, v1
v_mul_u32_u24 v42, 171, v41
v_lshrrev_b32 v42, 11, v42
v_mul_u32_u24 v43, 12, v42
v_sub_u32 v43, v41, v43
v_mul_u32_u24 v42, 3072, v42
v_lshrrev_b32 v44, 2, v43
v_lshl_add_u32 v42, v44, 10, v42
v_and_b32 v43, 3, v43
v_lshl_add_u32 v14, v43, 4, v42
v_add_u32 v41, 320, v1
v_mul_u32_u24 v42, 171, v41
v_lshrrev_b32 v42, 11, v42
v_mul_u32_u24 v43, 12, v42
v_sub_u32 v43, v41, v43
v_mul_u32_u24 v42, 3072, v42
v_lshrrev_b32 v44, 2, v43
v_lshl_add_u32 v42, v44, 10, v42
v_and_b32 v43, 3, v43
v_lshl_add_u32 v15, v43, 4, v42
v_subrev_u32 v15, 1024, v15
s_mul_i32 s56, s60, 22656
s_cmp_ge_u32 s60, 2
s_cselect_b32 s67, 18432, 0
s_add_u32 s56, s56, s67
s_add_u32 s56, s56, 18432
s_mov_b32 s58, 0
s_cmp_lt_u32 s64, 14
s_cselect_b32 s69, 1835008, 0
s_add_u32 s67, s66, s58
s_and_b32 s67, s67, 3
s_lshl_b32 s67, s67, 2
s_add_u32 s67, s67, s60
s_lshl_b32 s67, s67, 5
s_mul_i32 s53, s67, 3584
s_lshl_b32 s68, s64, 8
s_add_u32 s53, s53, s68
s_mul_i32 s54, s67, 3072
s_lshl_b32 s68, s64, 6
s_add_u32 s54, s54, s68
s_waitcnt lgkmcnt(0)
s_mov_b32 s24, s4
s_mov_b32 s25, s5
s_mov_b32 s26, 2097152
s_mov_b32 s27, 0x00020000
s_mov_b32 s28, s12
s_mov_b32 s29, s13
s_mov_b32 s30, s69
s_mov_b32 s31, 0x00020000
s_mov_b32 s12, s14
s_mov_b32 s13, s15
s_mov_b32 s14, s69
s_mov_b32 s15, 0x00020000
s_mov_b32 s32, s6
s_mov_b32 s33, s7
s_mov_b32 s34, 1572864
s_mov_b32 s35, 0x00020000
s_barrier
s_cmp_lg_u32 s60, 3
s_cbranch_scc1 H_NOPRE
s_lshl_b32 s68, s66, 8
s_mov_b32 s69, 63744
s_add_u32 m0, s69, s59
s_nop 0
buffer_load_dwordx4 v24, s[24:27], s68 offen lds
s_lshl_b32 s67, s59, 3
s_add_u32 s67, s67, s69
s_add_u32 m0, s67, 2048
s_nop 0
buffer_load_dwordx4 v16, s[24:27], s68 offen lds
buffer_load_dwordx4 v17, s[24:27], s68 offen offset:1024 lds
buffer_load_dwordx4 v18, s[24:27], s68 offen offset:2048 lds
buffer_load_dwordx4 v19, s[24:27], s68 offen offset:3072 lds
s_add_u32 m0, s67, 6144
s_nop 0
buffer_load_dwordx4 v20, s[24:27], s68 offen lds
buffer_load_dwordx4 v21, s[24:27], s68 offen offset:1024 lds
buffer_load_dwordx4 v22, s[24:27], s68 offen offset:2048 lds
buffer_load_dwordx4 v23, s[24:27], s68 offen offset:3072 lds
v_mov_b32 v28, 147408
v_mov_b32 v41, 1
s_waitcnt vmcnt(0)
s_mov_b64 exec, 1
ds_write_b32 v28, v41
s_mov_b64 exec, -1
s_branch H_GO0
H_NOPRE:
H_GO0:
s_add_u32 m0, s55, s59
s_nop 0
buffer_load_dwordx4 v24, s[24:27], s50 offen lds
s_lshl_b32 s67, s59, 3
s_add_u32 s67, s67, s55
s_add_u32 m0, s67, 2048
s_nop 0
buffer_load_dwordx4 v16, s[24:27], s50 offen lds
buffer_load_dwordx4 v17, s[24:27], s50 offen offset:1024 lds
buffer_load_dwordx4 v18, s[24:27], s50 offen offset:2048 lds
buffer_load_dwordx4 v19, s[24:27], s50 offen offset:3072 lds
s_add_u32 m0, s67, 6144
s_nop 0
buffer_load_dwordx4 v20, s[24:27], s50 offen lds
buffer_load_dwordx4 v21, s[24:27], s50 offen offset:1024 lds
buffer_load_dwordx4 v22, s[24:27], s50 offen offset:2048 lds
buffer_load_dwordx4 v23, s[24:27], s50 offen offset:3072 lds
s_add_u32 m0, s56, 16512
s_nop 0
buffer_load_dwordx4 v10, s[32:35], s54 offen lds
buffer_load_dwordx4 v11, s[32:35], s54 offen offset:1024 lds
buffer_load_dwordx4 v12, s[32:35], s54 offen offset:2048 lds
buffer_load_dwordx4 v13, s[32:35], s54 offen offset:3072 lds
s_add_u32 m0, s56, 20608
s_nop 0
buffer_load_dwordx4 v14, s[32:35], s54 offen lds
buffer_load_dwordx4 v15, s[32:35], s54 offen offset:1024 lds
s_add_u32 m0, s56, 0
s_nop 0
buffer_load_dwordx4 v2, s[28:31], s53 offen lds
buffer_load_dwordx4 v3, s[28:31], s53 offen offset:1024 lds
buffer_load_dwordx4 v4, s[28:31], s53 offen offset:2048 lds
buffer_load_dwordx4 v5, s[28:31], s53 offen offset:3072 lds
s_add_u32 m0, s56, 8320
s_nop 0
buffer_load_dwordx4 v2, s[12:15], s53 offen lds
buffer_load_dwordx4 v3, s[12:15], s53 offen offset:1024 lds
buffer_load_dwordx4 v4, s[12:15], s53 offen offset:2048 lds
buffer_load_dwordx4 v5, s[12:15], s53 offen offset:3072 lds
s_add_u32 m0, s56, 4096
s_nop 0
buffer_load_dwordx4 v6, s[28:31], s53 offen lds
buffer_load_dwordx4 v7, s[28:31], s53 offen offset:1024 lds
buffer_load_dwordx4 v8, s[28:31], s53 offen offset:2048 lds
buffer_load_dwordx4 v9, s[28:31], s53 offen offset:3072 lds
s_add_u32 m0, s56, 12416
s_nop 0
buffer_load_dwordx4 v6, s[12:15], s53 offen lds
buffer_load_dwordx4 v7, s[12:15], s53 offen offset:1024 lds
buffer_load_dwordx4 v8, s[12:15], s53 offen offset:2048 lds
buffer_load_dwordx4 v9, s[12:15], s53 offen offset:3072 lds
s_mov_b32 s36, s22
s_mov_b32 s37, s23
s_mov_b32 s38, 67108864
s_mov_b32 s39, 0x00020000
s_mov_b32 s40, s20
s_mov_b32 s41, s21
s_mov_b32 s42, 256
s_mov_b32 s43, 0x00020000
v_mov_b32 v36, 0
v_mov_b32 v34, 0
s_mov_b32 s73, 12582912
v_lshrrev_b32 v45, 5, v1
v_bfe_u32 v47, v1, 2, 2
v_and_b32 v48, 3, v1
v_lshl_add_u32 v51, v40, 3, v47
v_mul_u32_u24 v51, 192, v51
v_lshl_add_u32 v51, v48, 3, v51
s_add_u32 s70, s56, 16576
v_add_u32 v32, s70, v51
v_and_b32 v51, 15, v1
v_lshrrev_b32 v50, 1, v51
v_xor_b32 v50, v50, v40
v_lshlrev_b32 v51, 7, v51
v_lshl_add_u32 v39, v50, 4, v51
s_and_b32 s67, s60, 1
s_lshl_b32 s67, s67, 6
v_xor_b32 v39, s67, v39
s_lshr_b32 s67, s60, 1
s_add_u32 s67, s67, 1
s_mul_i32 s72, s67, 63744
v_add_u32 v33, s72, v39
v_mov_b32 v26, 147408
v_mov_b32 v28, 147408
v_and_b32 v27, 3, v1
v_lshlrev_b32 v27, 2, v27
v_add_u32 v27, 147440, v27
s_add_u32 s67, s60, 1
v_mov_b32 v30, s67
v_add_u32 v29, 1, v30
v_mov_b32 v31, s67
v_lshlrev_b32 v62, 2, v1
v_mov_b32 v144, 0
v_mov_b32 v145, 0
v_mov_b32 v146, 0
v_mov_b32 v147, 0
v_mov_b32 v148, 0
v_mov_b32 v149, 0
v_mov_b32 v150, 0
v_mov_b32 v151, 0
v_mov_b32 v152, 0
v_mov_b32 v153, 0
v_mov_b32 v154, 0
v_mov_b32 v155, 0
v_mov_b32 v156, 0
v_mov_b32 v157, 0
v_mov_b32 v158, 0
v_mov_b32 v159, 0
s_and_b32 s74, s63, 7
s_cmp_lg_u32 s74, s60
s_cselect_b32 s74, 0, 2
s_cbranch_scc1 H_NOPR
v_and_b32 v51, 15, v1
v_mov_b32 v50, 0x3f803f80
v_cmp_eq_u32 vcc, 0, v51
s_nop 1
v_cndmask_b32 v80, 0, v50, vcc
v_cndmask_b32 v81, 0, v50, vcc
v_mov_b64 v[82:83], v[80:81]
v_cmp_eq_u32 vcc, 1, v51
s_nop 1
v_cndmask_b32 v84, 0, v50, vcc
v_cndmask_b32 v85, 0, v50, vcc
v_mov_b64 v[86:87], v[84:85]
v_cmp_eq_u32 vcc, 2, v51
s_nop 1
v_cndmask_b32 v88, 0, v50, vcc
v_cndmask_b32 v89, 0, v50, vcc
v_mov_b64 v[90:91], v[88:89]
v_cmp_eq_u32 vcc, 3, v51
s_nop 1
v_cndmask_b32 v92, 0, v50, vcc
v_cndmask_b32 v93, 0, v50, vcc
v_mov_b64 v[94:95], v[92:93]
v_cmp_eq_u32 vcc, 4, v51
s_nop 1
v_cndmask_b32 v96, 0, v50, vcc
v_cndmask_b32 v97, 0, v50, vcc
v_mov_b64 v[98:99], v[96:97]
v_cmp_eq_u32 vcc, 5, v51
s_nop 1
v_cndmask_b32 v100, 0, v50, vcc
v_cndmask_b32 v101, 0, v50, vcc
v_mov_b64 v[102:103], v[100:101]
v_cmp_eq_u32 vcc, 6, v51
s_nop 1
v_cndmask_b32 v104, 0, v50, vcc
v_cndmask_b32 v105, 0, v50, vcc
v_mov_b64 v[106:107], v[104:105]
v_cmp_eq_u32 vcc, 7, v51
s_nop 1
v_cndmask_b32 v108, 0, v50, vcc
v_cndmask_b32 v109, 0, v50, vcc
v_mov_b64 v[110:111], v[108:109]
v_cmp_eq_u32 vcc, 8, v51
s_nop 1
v_cndmask_b32 v112, 0, v50, vcc
v_cndmask_b32 v113, 0, v50, vcc
v_mov_b64 v[114:115], v[112:113]
v_cmp_eq_u32 vcc, 9, v51
s_nop 1
v_cndmask_b32 v116, 0, v50, vcc
v_cndmask_b32 v117, 0, v50, vcc
v_mov_b64 v[118:119], v[116:117]
v_cmp_eq_u32 vcc, 10, v51
s_nop 1
v_cndmask_b32 v120, 0, v50, vcc
v_cndmask_b32 v121, 0, v50, vcc
v_mov_b64 v[122:123], v[120:121]
v_cmp_eq_u32 vcc, 11, v51
s_nop 1
v_cndmask_b32 v124, 0, v50, vcc
v_cndmask_b32 v125, 0, v50, vcc
v_mov_b64 v[126:127], v[124:125]
v_cmp_eq_u32 vcc, 12, v51
s_nop 1
v_cndmask_b32 v128, 0, v50, vcc
v_cndmask_b32 v129, 0, v50, vcc
v_mov_b64 v[130:131], v[128:129]
v_cmp_eq_u32 vcc, 13, v51
s_nop 1
v_cndmask_b32 v132, 0, v50, vcc
v_cndmask_b32 v133, 0, v50, vcc
v_mov_b64 v[134:135], v[132:133]
v_cmp_eq_u32 vcc, 14, v51
s_nop 1
v_cndmask_b32 v136, 0, v50, vcc
v_cndmask_b32 v137, 0, v50, vcc
v_mov_b64 v[138:139], v[136:137]
v_cmp_eq_u32 vcc, 15, v51
s_nop 1
v_cndmask_b32 v140, 0, v50, vcc
v_cndmask_b32 v141, 0, v50, vcc
v_mov_b64 v[142:143], v[140:141]
v_mov_b32 v64, 0
v_mov_b32 v65, 0
v_mov_b32 v66, 0
v_mov_b32 v67, 0
v_mov_b32 v68, 0
v_mov_b32 v69, 0
v_mov_b32 v70, 0
v_mov_b32 v71, 0
v_lshl_add_u32 v50, v40, 3, v47
v_lshlrev_b32 v50, 8, v50
v_lshl_add_u32 v50, v48, 3, v50
v_add_u32 v50, s56, v50
v_xor_b32 v49, 0, v47
v_lshl_add_u32 v73, v49, 5, v50
v_xor_b32 v49, 1, v47
v_lshl_add_u32 v74, v49, 5, v50
v_xor_b32 v49, 2, v47
v_lshl_add_u32 v75, v49, 5, v50
v_xor_b32 v49, 3, v47
v_lshl_add_u32 v76, v49, 5, v50
v_lshl_add_u32 v50, v51, 2, v40
v_lshlrev_b32 v34, 7, v50
v_subrev_u32 v35, 64, v32
s_mul_i32 s73, s64, 11264
s_lshl_b32 s67, s66, 1
s_add_u32 s67, s67, s60
s_lshl_b32 s67, s67, 4
s_add_u32 s73, s73, s67
s_add_u32 s73, s73, 11534336
H_NOPR:
s_lshl_b32 s75, s60, 1
s_lshl_b32 s48, s61, 2
s_and_b32 s67, s62, 3
s_add_u32 s48, s48, s67
s_lshr_b32 s49, s62, 2
s_mul_i32 s52, s75, 18
s_sub_i32 s67, s75, 2
s_max_i32 s67, s67, 0
s_min_i32 s67, s67, 2
s_lshl_b32 s67, s67, 1
s_add_u32 s52, s52, s67
s_sub_u32 s67, s75, 6
s_lshl_b32 s67, s67, 4
s_mov_b32 s46, 1835008
s_cmp_ge_u32 s75, 6
s_cselect_b32 s52, s67, s52
s_cselect_b32 s44, s8, s16
s_cselect_b32 s45, s9, s17
s_cselect_b32 s46, 524288, s46
s_mov_b32 s47, 0x00020000
s_lshl_b32 s71, s52, 14
s_lshl_b32 s67, s49, 7
s_add_u32 s71, s71, s67
s_lshl_b32 s68, s75, 11
s_add_u32 s75, s75, 1
s_lshl_b32 s48, s61, 2
s_and_b32 s67, s62, 3
s_add_u32 s48, s48, s67
s_lshr_b32 s49, s62, 2
s_mul_i32 s52, s75, 18
s_sub_i32 s67, s75, 2
s_max_i32 s67, s67, 0
s_min_i32 s67, s67, 2
s_lshl_b32 s67, s67, 1
s_add_u32 s52, s52, s67
s_sub_u32 s67, s75, 6
s_lshl_b32 s67, s67, 4
s_mov_b32 s46, 1835008
s_cmp_ge_u32 s75, 6
s_cselect_b32 s52, s67, s52
s_cselect_b32 s44, s8, s16
s_cselect_b32 s45, s9, s17
s_cselect_b32 s46, 524288, s46
s_mov_b32 s47, 0x00020000
s_lshl_b32 s69, s52, 14
s_lshl_b32 s67, s49, 7
s_add_u32 s69, s69, s67
s_lshl_b32 s68, s75, 11
s_sub_u32 s67, s69, s71
v_mul_lo_u32 v37, v45, s67
v_bfe_u32 v51, v1, 2, 3
v_lshl_add_u32 v37, v51, 14, v37
v_lshl_add_u32 v37, v48, 10, v37
s_and_b32 s67, s62, 3
s_lshl_b32 s67, s67, 12
s_add_u32 s71, s71, s67
s_branch H_V0
H_LOOP:
s_add_u32 s67, s66, s58
s_and_b32 s67, s67, 3
s_lshl_b32 s67, s67, 2
s_add_u32 s67, s67, s60
s_lshl_b32 s67, s67, 5
s_mul_i32 s53, s67, 3584
s_lshl_b32 s68, s64, 8
s_add_u32 s53, s53, s68
s_mul_i32 s54, s67, 3072
s_lshl_b32 s68, s64, 6
s_add_u32 s54, s54, s68
s_mov_b32 s67, 0
H_SP0:
ds_read_b32 v25, v27
s_add_u32 s67, s67, 1
s_waitcnt lgkmcnt(0)
v_cmp_gt_u32 vcc, v31, v25
s_cmp_gt_u32 s67, 200000
s_cbranch_vccz H_SP0D
s_cbranch_scc1 H_SP0D
s_sleep 1
s_branch H_SP0
H_SP0D:
s_lshl_b32 s67, s58, 2
s_add_u32 s67, s67, s60
s_cmp_eq_u32 s67, 15
s_cbranch_scc1 H_NOX
s_add_u32 m0, s55, s59
s_nop 0
buffer_load_dwordx4 v24, s[24:27], s50 offen lds
s_lshl_b32 s67, s59, 3
s_add_u32 s67, s67, s55
s_add_u32 m0, s67, 2048
s_nop 0
buffer_load_dwordx4 v16, s[24:27], s50 offen lds
buffer_load_dwordx4 v17, s[24:27], s50 offen offset:1024 lds
buffer_load_dwordx4 v18, s[24:27], s50 offen offset:2048 lds
buffer_load_dwordx4 v19, s[24:27], s50 offen offset:3072 lds
s_add_u32 m0, s67, 6144
s_nop 0
buffer_load_dwordx4 v20, s[24:27], s50 offen lds
buffer_load_dwordx4 v21, s[24:27], s50 offen offset:1024 lds
buffer_load_dwordx4 v22, s[24:27], s50 offen offset:2048 lds
buffer_load_dwordx4 v23, s[24:27], s50 offen offset:3072 lds
H_NOX:
s_add_u32 m0, s56, 16512
s_nop 0
buffer_load_dwordx4 v10, s[32:35], s54 offen lds
buffer_load_dwordx4 v11, s[32:35], s54 offen offset:1024 lds
buffer_load_dwordx4 v12, s[32:35], s54 offen offset:2048 lds
buffer_load_dwordx4 v13, s[32:35], s54 offen offset:3072 lds
s_add_u32 m0, s56, 20608
s_nop 0
buffer_load_dwordx4 v14, s[32:35], s54 offen lds
buffer_load_dwordx4 v15, s[32:35], s54 offen offset:1024 lds
s_add_u32 m0, s56, 0
s_nop 0
buffer_load_dwordx4 v2, s[28:31], s53 offen lds
buffer_load_dwordx4 v3, s[28:31], s53 offen offset:1024 lds
buffer_load_dwordx4 v4, s[28:31], s53 offen offset:2048 lds
buffer_load_dwordx4 v5, s[28:31], s53 offen offset:3072 lds
s_add_u32 m0, s56, 8320
s_nop 0
buffer_load_dwordx4 v2, s[12:15], s53 offen lds
buffer_load_dwordx4 v3, s[12:15], s53 offen offset:1024 lds
buffer_load_dwordx4 v4, s[12:15], s53 offen offset:2048 lds
buffer_load_dwordx4 v5, s[12:15], s53 offen offset:3072 lds
s_add_u32 m0, s56, 4096
s_nop 0
buffer_load_dwordx4 v6, s[28:31], s53 offen lds
buffer_load_dwordx4 v7, s[28:31], s53 offen offset:1024 lds
buffer_load_dwordx4 v8, s[28:31], s53 offen offset:2048 lds
buffer_load_dwordx4 v9, s[28:31], s53 offen offset:3072 lds
s_add_u32 m0, s56, 12416
s_nop 0
buffer_load_dwordx4 v6, s[12:15], s53 offen lds
buffer_load_dwordx4 v7, s[12:15], s53 offen offset:1024 lds
buffer_load_dwordx4 v8, s[12:15], s53 offen offset:2048 lds
buffer_load_dwordx4 v9, s[12:15], s53 offen offset:3072 lds
v_add_u32 v31, 4, v31
H_V0:
s_waitcnt vmcnt(0)
H_MID:
s_mov_b32 s67, 0
H_SP1:
ds_read_b32 v25, v26
s_add_u32 s67, s67, 1
s_waitcnt lgkmcnt(0)
v_cmp_gt_u32 vcc, v30, v25
s_cmp_gt_u32 s67, 200000
s_cbranch_vccz H_SP1D
s_cbranch_scc1 H_SP1D
s_sleep 0
s_branch H_SP1
H_SP1D:
ds_read_b64_tr_b16 v[160:161], v32 offset:0
ds_read_b64_tr_b16 v[162:163], v32 offset:768
ds_read_b64_tr_b16 v[164:165], v32 offset:32
ds_read_b64_tr_b16 v[166:167], v32 offset:800
ds_read_b64_tr_b16 v[168:169], v32 offset:64
ds_read_b64_tr_b16 v[170:171], v32 offset:832
ds_read_b64_tr_b16 v[172:173], v32 offset:96
ds_read_b64_tr_b16 v[174:175], v32 offset:864
ds_read_b128 v[176:179], v33
s_mov_b64 exec, 1
ds_write_b32 v28, v29
s_mov_b64 exec, -1
s_cmp_lg_u32 s58, 0
s_cbranch_scc1 H_NOGI
buffer_load_dword v72, v36, s[40:43], 0 offen
H_NOGI:
s_cmp_lt_u32 s58, 1
s_cbranch_scc1 H_NOPF
buffer_load_dword v38, v37, s[44:47], s71 offen
s_add_u32 s71, s71, 131072
H_NOPF:
s_sub_u32 s55, s55, 63744
s_cselect_b32 s67, 191232, 0
s_add_u32 s55, s55, s67
s_add_u32 s50, s50, 256
s_and_b32 s50, s50, 1023
v_add_u32 v30, 4, v30
v_add_u32 v29, 4, v29
s_sub_u32 s72, s72, 63744
s_cselect_b32 s67, 191232, 0
s_add_u32 s72, s72, s67
s_waitcnt lgkmcnt(0)
s_setprio 3
v_mfma_f32_16x16x32_bf16 v[144:147], v[160:163], v[176:179], v[144:147]
v_mfma_f32_16x16x32_bf16 v[148:151], v[164:167], v[176:179], v[148:151]
v_mfma_f32_16x16x32_bf16 v[152:155], v[168:171], v[176:179], v[152:155]
v_mfma_f32_16x16x32_bf16 v[156:159], v[172:175], v[176:179], v[156:159]
s_setprio 0
v_add_u32 v33, s72, v39
s_cmp_lt_u32 s58, s74
s_cbranch_scc1 H_CSUM
H_CSD:
s_cmp_eq_u32 s58, 1
s_cbranch_scc1 H_STATS
H_STD:
s_add_u32 s58, s58, 1
s_cmp_lt_u32 s58, 4
s_cbranch_scc1 H_LOOP
v_lshrrev_b32 v3, 3, v1
v_and_b32 v4, 7, v1
v_bfe_u32 v5, v1, 4, 1
v_lshlrev_b32 v5, 2, v5
v_xor_b32 v4, v4, v5
v_lshlrev_b32 v3, 10, v3
v_lshl_add_u32 v2, v4, 4, v3
s_mul_i32 s73, s64, 11264
s_add_u32 s73, s73, 11534336
s_mul_i32 s68, s65, 192
s_mov_b32 s57, 10485760
v_add_u32 v3, s68, v1
v_add_u32 v4, 64, v3
v_add_u32 v5, 64, v4
v_min_u32 v10, 703, v3
v_lshlrev_b32 v10, 4, v10
v_min_u32 v11, 703, v4
v_lshlrev_b32 v11, 4, v11
v_min_u32 v12, 703, v5
v_lshlrev_b32 v12, 4, v12
s_lshl_b32 s67, s63, 7
s_sub_u32 s67, s67, 16
v_and_b32 v9, 15, v1
v_add_u32 v9, s67, v9
v_max_i32 v9, 0, v9
v_lshlrev_b32 v9, 3, v9
s_mov_b32 s58, s73
buffer_load_dwordx4 v[184:187], v10, s[36:39], s58 offen sc0 sc1
buffer_load_dwordx4 v[188:191], v11, s[36:39], s58 offen sc0 sc1
buffer_load_dwordx4 v[192:195], v12, s[36:39], s58 offen sc0 sc1
buffer_load_dwordx2 v[208:209], v9, s[36:39], s57 offen sc0 sc1
s_lshr_b32 s67, s60, 1
s_lshl_b32 s67, s67, 13
s_and_b32 s68, s60, 1
s_lshl_b32 s68, s68, 10
s_add_u32 s67, s67, s68
s_add_u32 s67, s67, 147456
v_lshlrev_b32 v42, 4, v1
v_add_u32 v42, s67, v42
ds_write_b128 v42, v[144:147] offset:0
ds_write_b128 v42, v[148:151] offset:2048
ds_write_b128 v42, v[152:155] offset:4096
ds_write_b128 v42, v[156:159] offset:6144
v_min_u32 v3, 704, v3
v_and_b32 v3, 0xfffffff8, v3
v_lshlrev_b32 v3, 1, v3
v_add_u32 v3, 145920, v3
v_min_u32 v4, 704, v4
v_and_b32 v4, 0xfffffff8, v4
v_lshlrev_b32 v4, 1, v4
v_add_u32 v4, 145920, v4
v_min_u32 v5, 704, v5
v_and_b32 v5, 0xfffffff8, v5
v_lshlrev_b32 v5, 1, v5
v_add_u32 v5, 145920, v5
v_mov_b32 v43, 0x0c0c0400
v_mov_b32 v44, 0x04000c0c
s_mov_b32 s56, 0
s_add_u32 s75, s60, 4
s_lshl_b32 s48, s61, 2
s_and_b32 s67, s62, 3
s_add_u32 s48, s48, s67
s_lshr_b32 s49, s62, 2
s_mul_i32 s52, s75, 18
s_sub_i32 s67, s75, 2
s_max_i32 s67, s67, 0
s_min_i32 s67, s67, 2
s_lshl_b32 s67, s67, 1
s_add_u32 s52, s52, s67
s_sub_u32 s67, s75, 6
s_lshl_b32 s67, s67, 4
s_mov_b32 s6, 1835008
s_cmp_ge_u32 s75, 6
s_cselect_b32 s52, s67, s52
s_cselect_b32 s4, s8, s16
s_cselect_b32 s5, s9, s17
s_cselect_b32 s6, 524288, s6
s_mov_b32 s7, 0x00020000
s_lshl_b32 s20, s52, 14
s_lshl_b32 s67, s49, 7
s_add_u32 s20, s20, s67
s_lshl_b32 s21, s75, 11
s_lshl_b32 s48, s61, 2
s_and_b32 s67, s62, 3
s_add_u32 s48, s48, s67
s_lshr_b32 s49, s62, 2
s_mul_i32 s52, s60, 18
s_sub_i32 s67, s60, 2
s_max_i32 s67, s67, 0
s_min_i32 s67, s67, 2
s_lshl_b32 s67, s67, 1
s_add_u32 s52, s52, s67
s_lshr_b32 s67, s60, 1
s_cmp_eq_u32 s67, 1
s_cselect_b32 s51, 20, 18
s_add_u32 s74, s52, 32
s_mov_b32 s59, 0x02020202
s_sub_u32 s67, s60, 6
s_lshl_b32 s67, s67, 4
s_mov_b32 s46, 1835008
s_cmp_ge_u32 s60, 6
s_cselect_b32 s52, s67, s52
s_cselect_b32 s51, 16, s51
s_cselect_b32 s74, s67, s74
s_cselect_b32 s59, 0x04040404, s59
s_cselect_b32 s44, s8, s16
s_cselect_b32 s45, s9, s17
s_cselect_b32 s46, 524288, s46
s_mov_b32 s47, 0x00020000
s_lshl_b32 s73, s52, 14
s_lshl_b32 s67, s49, 7
s_add_u32 s73, s73, s67
s_lshl_b32 s69, s60, 11
s_mul_i32 s67, s48, 288
s_add_u32 s74, s74, s67
s_lshl_b32 s74, s74, 10
s_add_u32 s73, s73, 16384
s_add_u32 s20, s20, 16384
s_mov_b32 s67, 0
H_SP2:
ds_read_b32 v25, v27
s_add_u32 s67, s67, 1
s_waitcnt lgkmcnt(0)
v_cmp_gt_u32 vcc, 12, v25
s_cmp_gt_u32 s67, 200000
s_cbranch_vccz H_SP2D
s_cbranch_scc1 H_SP2D
s_sleep 1
s_branch H_SP2
H_SP2D:
s_add_u32 m0, s69, 0
s_nop 0
buffer_load_dwordx4 v2, s[44:47], s73 offen lds
s_add_u32 s73, s73, 8192
s_add_u32 m0, s69, 1024
s_nop 0
buffer_load_dwordx4 v2, s[44:47], s73 offen lds
s_add_u32 s73, s73, 8192
s_add_u32 m0, s21, 0
s_nop 0
buffer_load_dwordx4 v2, s[4:7], s20 offen lds
s_add_u32 s20, s20, 8192
s_add_u32 m0, s21, 1024
s_nop 0
buffer_load_dwordx4 v2, s[4:7], s20 offen lds
s_add_u32 s20, s20, 8192
s_mov_b32 s67, 0
H_SP3:
ds_read_b32 v25, v27
s_add_u32 s67, s67, 1
s_waitcnt lgkmcnt(0)
v_cmp_gt_u32 vcc, 13, v25
s_cmp_gt_u32 s67, 200000
s_cbranch_vccz H_SP3D
s_cbranch_scc1 H_SP3D
s_sleep 1
s_branch H_SP3
H_SP3D:
s_add_u32 m0, s69, 16384
s_nop 0
buffer_load_dwordx4 v2, s[44:47], s73 offen lds
s_add_u32 s73, s73, 8192
s_add_u32 m0, s69, 17408
s_nop 0
buffer_load_dwordx4 v2, s[44:47], s73 offen lds
s_add_u32 s73, s73, 8192
s_add_u32 m0, s21, 16384
s_nop 0
buffer_load_dwordx4 v2, s[4:7], s20 offen lds
s_add_u32 s20, s20, 8192
s_add_u32 m0, s21, 17408
s_nop 0
buffer_load_dwordx4 v2, s[4:7], s20 offen lds
s_add_u32 s20, s20, 8192
s_waitcnt vmcnt(8)
H_CSC:
v_cmp_ne_u32 s[54:55], v209, v72
v_perm_b32 v41, v185, v184, v43
v_perm_b32 v42, v187, v186, v44
v_or_b32 v41, v41, v42
v_cmp_ne_u32 vcc, v41, v72
s_nop 0
s_or_b64 s[54:55], s[54:55], vcc
v_perm_b32 v41, v189, v188, v43
v_perm_b32 v42, v191, v190, v44
v_or_b32 v41, v41, v42
v_cmp_ne_u32 vcc, v41, v72
s_nop 0
s_or_b64 s[54:55], s[54:55], vcc
v_perm_b32 v41, v193, v192, v43
v_perm_b32 v42, v195, v194, v44
v_or_b32 v41, v41, v42
v_cmp_ne_u32 vcc, v41, v72
s_nop 0
s_or_b64 s[54:55], s[54:55], vcc
s_cmp_lg_u64 s[54:55], 0
s_cbranch_scc1 H_CSR
H_CSOK:
v_and_b32 v184, 0xffffff00, v184
v_and_b32 v185, 0xffffff00, v185
v_and_b32 v186, 0xffffff00, v186
v_and_b32 v187, 0xffffff00, v187
v_and_b32 v188, 0xffffff00, v188
v_and_b32 v189, 0xffffff00, v189
v_and_b32 v190, 0xffffff00, v190
v_and_b32 v191, 0xffffff00, v191
v_and_b32 v192, 0xffffff00, v192
v_and_b32 v193, 0xffffff00, v193
v_and_b32 v194, 0xffffff00, v194
v_and_b32 v195, 0xffffff00, v195
v_lshlrev_b32 v209, 16, v208
v_and_b32 v208, 0xffff0000, v208
v_rcp_f32 v209, v209
v_readfirstlane_b32 s75, v72
v_add_f32_dpp v184, v184, v184 quad_perm:[1,0,3,2] row_mask:0xf bank_mask:0xf
v_add_f32_dpp v185, v185, v185 quad_perm:[1,0,3,2] row_mask:0xf bank_mask:0xf
v_add_f32_dpp v186, v186, v186 quad_perm:[1,0,3,2] row_mask:0xf bank_mask:0xf
v_add_f32_dpp v187, v187, v187 quad_perm:[1,0,3,2] row_mask:0xf bank_mask:0xf
v_add_f32_dpp v188, v188, v188 quad_perm:[1,0,3,2] row_mask:0xf bank_mask:0xf
v_add_f32_dpp v189, v189, v189 quad_perm:[1,0,3,2] row_mask:0xf bank_mask:0xf
v_add_f32_dpp v190, v190, v190 quad_perm:[1,0,3,2] row_mask:0xf bank_mask:0xf
v_add_f32_dpp v191, v191, v191 quad_perm:[1,0,3,2] row_mask:0xf bank_mask:0xf
v_add_f32_dpp v192, v192, v192 quad_perm:[1,0,3,2] row_mask:0xf bank_mask:0xf
v_add_f32_dpp v193, v193, v193 quad_perm:[1,0,3,2] row_mask:0xf bank_mask:0xf
v_add_f32_dpp v194, v194, v194 quad_perm:[1,0,3,2] row_mask:0xf bank_mask:0xf
v_add_f32_dpp v195, v195, v195 quad_perm:[1,0,3,2] row_mask:0xf bank_mask:0xf
v_add_f32_dpp v184, v184, v184 quad_perm:[2,3,0,1] row_mask:0xf bank_mask:0xf
v_add_f32_dpp v185, v185, v185 quad_perm:[2,3,0,1] row_mask:0xf bank_mask:0xf
v_add_f32_dpp v186, v186, v186 quad_perm:[2,3,0,1] row_mask:0xf bank_mask:0xf
v_add_f32_dpp v187, v187, v187 quad_perm:[2,3,0,1] row_mask:0xf bank_mask:0xf
v_add_f32_dpp v188, v188, v188 quad_perm:[2,3,0,1] row_mask:0xf bank_mask:0xf
v_add_f32_dpp v189, v189, v189 quad_perm:[2,3,0,1] row_mask:0xf bank_mask:0xf
v_add_f32_dpp v190, v190, v190 quad_perm:[2,3,0,1] row_mask:0xf bank_mask:0xf
v_add_f32_dpp v191, v191, v191 quad_perm:[2,3,0,1] row_mask:0xf bank_mask:0xf
v_add_f32_dpp v192, v192, v192 quad_perm:[2,3,0,1] row_mask:0xf bank_mask:0xf
v_add_f32_dpp v193, v193, v193 quad_perm:[2,3,0,1] row_mask:0xf bank_mask:0xf
v_add_f32_dpp v194, v194, v194 quad_perm:[2,3,0,1] row_mask:0xf bank_mask:0xf
v_add_f32_dpp v195, v195, v195 quad_perm:[2,3,0,1] row_mask:0xf bank_mask:0xf
v_add_f32_dpp v184, v184, v184 row_half_mirror row_mask:0xf bank_mask:0xf
v_add_f32_dpp v185, v185, v185 row_half_mirror row_mask:0xf bank_mask:0xf
v_add_f32_dpp v186, v186, v186 row_half_mirror row_mask:0xf bank_mask:0xf
v_add_f32_dpp v187, v187, v187 row_half_mirror row_mask:0xf bank_mask:0xf
v_add_f32_dpp v188, v188, v188 row_half_mirror row_mask:0xf bank_mask:0xf
v_add_f32_dpp v189, v189, v189 row_half_mirror row_mask:0xf bank_mask:0xf
v_add_f32_dpp v190, v190, v190 row_half_mirror row_mask:0xf bank_mask:0xf
v_add_f32_dpp v191, v191, v191 row_half_mirror row_mask:0xf bank_mask:0xf
v_add_f32_dpp v192, v192, v192 row_half_mirror row_mask:0xf bank_mask:0xf
v_add_f32_dpp v193, v193, v193 row_half_mirror row_mask:0xf bank_mask:0xf
v_add_f32_dpp v194, v194, v194 row_half_mirror row_mask:0xf bank_mask:0xf
v_add_f32_dpp v195, v195, v195 row_half_mirror row_mask:0xf bank_mask:0xf
v_cvt_pk_bf16_f32 v196, v184, v184
v_cvt_pk_bf16_f32 v197, v185, v185
v_cvt_pk_bf16_f32 v198, v186, v186
v_cvt_pk_bf16_f32 v199, v187, v187
v_cvt_pk_bf16_f32 v200, v188, v188
v_cvt_pk_bf16_f32 v201, v189, v189
v_cvt_pk_bf16_f32 v202, v190, v190
v_cvt_pk_bf16_f32 v203, v191, v191
v_cvt_pk_bf16_f32 v204, v192, v192
v_cvt_pk_bf16_f32 v205, v193, v193
v_cvt_pk_bf16_f32 v206, v194, v194
v_cvt_pk_bf16_f32 v207, v195, v195
v_lshlrev_b32 v196, 16, v196
v_lshlrev_b32 v197, 16, v197
v_lshlrev_b32 v198, 16, v198
v_lshlrev_b32 v199, 16, v199
v_lshlrev_b32 v200, 16, v200
v_lshlrev_b32 v201, 16, v201
v_lshlrev_b32 v202, 16, v202
v_lshlrev_b32 v203, 16, v203
v_lshlrev_b32 v204, 16, v204
v_lshlrev_b32 v205, 16, v205
v_lshlrev_b32 v206, 16, v206
v_lshlrev_b32 v207, 16, v207
v_sub_f32 v196, v184, v196
v_sub_f32 v197, v185, v197
v_sub_f32 v198, v186, v198
v_sub_f32 v199, v187, v199
v_sub_f32 v200, v188, v200
v_sub_f32 v201, v189, v201
v_sub_f32 v202, v190, v202
v_sub_f32 v203, v191, v203
v_sub_f32 v204, v192, v204
v_sub_f32 v205, v193, v205
v_sub_f32 v206, v194, v206
v_sub_f32 v207, v195, v207
v_cvt_pk_bf16_f32 v184, -v184, -v196
v_cvt_pk_bf16_f32 v185, -v185, -v197
v_cvt_pk_bf16_f32 v186, -v186, -v198
v_cvt_pk_bf16_f32 v187, -v187, -v199
v_cvt_pk_bf16_f32 v188, -v188, -v200
v_cvt_pk_bf16_f32 v189, -v189, -v201
v_cvt_pk_bf16_f32 v190, -v190, -v202
v_cvt_pk_bf16_f32 v191, -v191, -v203
v_cvt_pk_bf16_f32 v192, -v192, -v204
v_cvt_pk_bf16_f32 v193, -v193, -v205
v_cvt_pk_bf16_f32 v194, -v194, -v206
v_cvt_pk_bf16_f32 v195, -v195, -v207
ds_write_b128 v3, v[184:187]
ds_write_b128 v4, v[188:191]
ds_write_b128 v5, v[192:195]
s_mov_b32 s67, 0
H_SP4:
ds_read_b32 v25, v27
s_add_u32 s67, s67, 1
s_waitcnt lgkmcnt(0)
v_cmp_gt_u32 vcc, 14, v25
s_cmp_gt_u32 s67, 200000
s_cbranch_vccz H_SP4D
s_cbranch_scc1 H_SP4D
s_sleep 1
s_branch H_SP4
H_SP4D:
s_add_u32 m0, s69, 32768
s_nop 0
buffer_load_dwordx4 v2, s[44:47], s73 offen lds
s_add_u32 s73, s73, 8192
s_add_u32 m0, s69, 33792
s_nop 0
buffer_load_dwordx4 v2, s[44:47], s73 offen lds
s_add_u32 s73, s73, 8192
s_add_u32 m0, s21, 32768
s_nop 0
buffer_load_dwordx4 v2, s[4:7], s20 offen lds
s_add_u32 s20, s20, 8192
s_add_u32 m0, s21, 33792
s_nop 0
buffer_load_dwordx4 v2, s[4:7], s20 offen lds
s_add_u32 s20, s20, 8192
s_add_u32 m0, s69, 49152
s_nop 0
buffer_load_dwordx4 v2, s[44:47], s73 offen lds
s_add_u32 s73, s73, 8192
s_add_u32 m0, s69, 50176
s_nop 0
buffer_load_dwordx4 v2, s[44:47], s73 offen lds
s_add_u32 s73, s73, 8192
s_add_u32 m0, s21, 49152
s_nop 0
buffer_load_dwordx4 v2, s[4:7], s20 offen lds
s_add_u32 s20, s20, 8192
s_add_u32 m0, s21, 50176
s_nop 0
buffer_load_dwordx4 v2, s[4:7], s20 offen lds
s_add_u32 s20, s20, 8192
s_add_u32 m0, s69, 65536
s_nop 0
buffer_load_dwordx4 v2, s[44:47], s73 offen lds
s_add_u32 s73, s73, 8192
s_add_u32 m0, s69, 66560
s_nop 0
buffer_load_dwordx4 v2, s[44:47], s73 offen lds
s_add_u32 s73, s73, 8192
s_add_u32 m0, s21, 65536
s_nop 0
buffer_load_dwordx4 v2, s[4:7], s20 offen lds
s_add_u32 s20, s20, 8192
s_add_u32 m0, s21, 66560
s_nop 0
buffer_load_dwordx4 v2, s[4:7], s20 offen lds
s_add_u32 s20, s20, 8192
s_mov_b32 s67, 0
H_SP5:
ds_read_b32 v25, v27
s_add_u32 s67, s67, 1
s_waitcnt lgkmcnt(0)
v_cmp_gt_u32 vcc, 15, v25
s_cmp_gt_u32 s67, 200000
s_cbranch_vccz H_SP5D
s_cbranch_scc1 H_SP5D
s_sleep 1
s_branch H_SP5
H_SP5D:
s_add_u32 m0, s69, 81920
s_nop 0
buffer_load_dwordx4 v2, s[44:47], s73 offen lds
s_add_u32 s73, s73, 8192
s_add_u32 m0, s69, 82944
s_nop 0
buffer_load_dwordx4 v2, s[44:47], s73 offen lds
s_add_u32 s73, s73, 8192
s_add_u32 m0, s21, 81920
s_nop 0
buffer_load_dwordx4 v2, s[4:7], s20 offen lds
s_add_u32 s20, s20, 8192
s_add_u32 m0, s21, 82944
s_nop 0
buffer_load_dwordx4 v2, s[4:7], s20 offen lds
s_add_u32 s20, s20, 8192
v_lshrrev_b32 v10, 4, v1
v_lshlrev_b32 v10, 4, v10
s_lshl_b32 s70, s65, 6
s_add_u32 s70, s70, 146048
v_add_u32 v10, s70, v10
v_lshlrev_b32 v8, 4, v1
s_add_u32 s70, s69, 147456
v_add_u32 v11, s70, v8
s_mov_b32 s67, 0
H_SP6:
ds_read_b32 v25, v27
s_add_u32 s67, s67, 1
s_waitcnt lgkmcnt(0)
v_cmp_gt_u32 vcc, 16, v25
s_cmp_gt_u32 s67, 200000
s_cbranch_vccz H_SP6D
s_cbranch_scc1 H_SP6D
s_sleep 1
s_branch H_SP6
H_SP6D:
s_add_u32 m0, s69, 98304
s_nop 0
buffer_load_dwordx4 v2, s[44:47], s73 offen lds
s_add_u32 s73, s73, 8192
s_add_u32 m0, s69, 99328
s_nop 0
buffer_load_dwordx4 v2, s[44:47], s73 offen lds
s_add_u32 s73, s73, 8192
s_add_u32 m0, s21, 98304
s_nop 0
buffer_load_dwordx4 v2, s[4:7], s20 offen lds
s_add_u32 s20, s20, 8192
s_add_u32 m0, s21, 99328
s_nop 0
buffer_load_dwordx4 v2, s[4:7], s20 offen lds
s_add_u32 s20, s20, 8192
s_barrier
ds_read_b128 v[144:147], v11 offset:0
ds_read_b128 v[148:151], v11 offset:1024
ds_read_b128 v[152:155], v11 offset:8192
ds_read_b128 v[156:159], v11 offset:9216
ds_read_b128 v[160:163], v10
s_waitcnt lgkmcnt(0)
s_sub_u32 s67, s73, 131072
s_add_u32 m0, s69, 147456
s_nop 0
buffer_load_dwordx4 v2, s[44:47], s67 offen lds
s_add_u32 s67, s67, 8192
s_add_u32 m0, s69, 148480
s_nop 0
buffer_load_dwordx4 v2, s[44:47], s67 offen lds
s_add_u32 s67, s67, 8192
s_sub_u32 s67, s20, 131072
s_add_u32 m0, s21, 147456
s_nop 0
buffer_load_dwordx4 v2, s[4:7], s67 offen lds
s_add_u32 s67, s67, 8192
s_add_u32 m0, s21, 148480
s_nop 0
buffer_load_dwordx4 v2, s[4:7], s67 offen lds
s_add_u32 s67, s67, 8192
v_add_f32 v144, v144, v148
v_add_f32 v152, v152, v156
v_add_f32 v145, v145, v149
v_add_f32 v153, v153, v157
v_add_f32 v146, v146, v150
v_add_f32 v154, v154, v158
v_add_f32 v147, v147, v151
v_add_f32 v155, v155, v159
v_add_f32 v144, v144, v152
v_add_f32 v145, v145, v153
v_add_f32 v146, v146, v154
v_add_f32 v147, v147, v155
v_lshlrev_b32 v196, 16, v160
v_and_b32 v160, 0xffff0000, v160
v_lshlrev_b32 v197, 16, v161
v_and_b32 v161, 0xffff0000, v161
v_lshlrev_b32 v198, 16, v162
v_and_b32 v162, 0xffff0000, v162
v_lshlrev_b32 v199, 16, v163
v_and_b32 v163, 0xffff0000, v163
v_add_f32 v160, v160, v196
v_add_f32 v161, v161, v197
v_add_f32 v162, v162, v198
v_add_f32 v163, v163, v199
v_fma_f32 v144, v208, v160, v144
v_fma_f32 v145, v208, v161, v145
v_fma_f32 v146, v208, v162, v146
v_fma_f32 v147, v208, v163, v147
v_mul_f32 v144, v209, v144
v_mul_f32 v145, v209, v145
v_mul_f32 v146, v209, v146
v_mul_f32 v147, v209, v147
v_cvt_pk_bf16_f32 v164, v144, v145
v_cvt_pk_bf16_f32 v165, v146, v147
v_and_b32 v10, 15, v1
v_mul_u32_u24 v10, 208, v10
v_bfe_u32 v12, v1, 4, 1
v_lshl_add_u32 v10, v12, 4, v10
v_lshrrev_b32 v12, 5, v1
v_lshl_add_u32 v10, v12, 3, v10
s_lshl_b32 s70, s65, 5
s_add_u32 s70, s70, 114752
v_add_u32 v10, s70, v10
ds_write_b64 v10, v[164:165]
v_mov_b32 v21, 147392
v_mov_b32 v22, 1
s_mov_b64 exec, 1
s_waitcnt lgkmcnt(0)
ds_add_u32 v21, v22
s_mov_b64 exec, -1
s_branch ATT
H_CSR:
s_add_u32 s56, s56, 1
s_cmp_gt_u32 s56, 100000
s_cbranch_scc1 H_CSOK
s_sleep 2
buffer_load_dwordx4 v[184:187], v10, s[36:39], s58 offen sc0 sc1
buffer_load_dwordx4 v[188:191], v11, s[36:39], s58 offen sc0 sc1
buffer_load_dwordx4 v[192:195], v12, s[36:39], s58 offen sc0 sc1
buffer_load_dwordx2 v[208:209], v9, s[36:39], s57 offen sc0 sc1
s_waitcnt vmcnt(0)
s_branch H_CSC
H_CSUM:
ds_read_b64_tr_b16 v[184:185], v35 offset:0
ds_read_b64_tr_b16 v[186:187], v35 offset:768
ds_read_b64_tr_b16 v[188:189], v35 offset:32
ds_read_b64_tr_b16 v[190:191], v35 offset:800
ds_read_b64_tr_b16 v[192:193], v35 offset:64
ds_read_b64_tr_b16 v[194:195], v35 offset:832
ds_read_b64_tr_b16 v[196:197], v35 offset:96
ds_read_b64_tr_b16 v[198:199], v35 offset:864
ds_read_b64_tr_b16 v[200:201], v35 offset:128
ds_read_b64_tr_b16 v[202:203], v35 offset:896
ds_read_b64_tr_b16 v[204:205], v35 offset:160
ds_read_b64_tr_b16 v[206:207], v35 offset:928
s_setprio 3
s_waitcnt lgkmcnt(10)
v_mfma_f32_16x16x32_bf16 v[64:67], v[184:187], v[80:83], v[64:67]
ds_read_b64_tr_b16 v[208:209], v73 offset:0
ds_read_b64_tr_b16 v[210:211], v73 offset:1024
s_waitcnt lgkmcnt(10)
v_mfma_f32_16x16x32_bf16 v[64:67], v[188:191], v[84:87], v[64:67]
ds_read_b64_tr_b16 v[212:213], v73 offset:8320
ds_read_b64_tr_b16 v[214:215], v73 offset:9344
s_waitcnt lgkmcnt(10)
v_mfma_f32_16x16x32_bf16 v[64:67], v[192:195], v[88:91], v[64:67]
ds_read_b64_tr_b16 v[184:185], v74 offset:0
ds_read_b64_tr_b16 v[186:187], v74 offset:1024
s_waitcnt lgkmcnt(10)
v_mfma_f32_16x16x32_bf16 v[64:67], v[196:199], v[92:95], v[64:67]
ds_read_b64_tr_b16 v[188:189], v74 offset:8320
ds_read_b64_tr_b16 v[190:191], v74 offset:9344
s_waitcnt lgkmcnt(10)
v_mfma_f32_16x16x32_bf16 v[64:67], v[200:203], v[96:99], v[64:67]
ds_read_b64_tr_b16 v[192:193], v75 offset:0
ds_read_b64_tr_b16 v[194:195], v75 offset:1024
s_waitcnt lgkmcnt(10)
v_mfma_f32_16x16x32_bf16 v[64:67], v[204:207], v[100:103], v[64:67]
ds_read_b64_tr_b16 v[196:197], v75 offset:8320
ds_read_b64_tr_b16 v[198:199], v75 offset:9344
s_waitcnt lgkmcnt(10)
v_mfma_f32_16x16x32_bf16 v[64:67], v[208:211], v[104:107], v[64:67]
ds_read_b64_tr_b16 v[200:201], v76 offset:0
ds_read_b64_tr_b16 v[202:203], v76 offset:1024
s_waitcnt lgkmcnt(10)
v_mfma_f32_16x16x32_bf16 v[64:67], v[212:215], v[108:111], v[64:67]
ds_read_b64_tr_b16 v[204:205], v76 offset:8320
ds_read_b64_tr_b16 v[206:207], v76 offset:9344
s_waitcnt lgkmcnt(10)
v_mfma_f32_16x16x32_bf16 v[64:67], v[184:187], v[112:115], v[64:67]
ds_read_b64_tr_b16 v[208:209], v73 offset:128
ds_read_b64_tr_b16 v[210:211], v73 offset:1152
s_waitcnt lgkmcnt(10)
v_mfma_f32_16x16x32_bf16 v[64:67], v[188:191], v[116:119], v[64:67]
ds_read_b64_tr_b16 v[212:213], v73 offset:8448
ds_read_b64_tr_b16 v[214:215], v73 offset:9472
s_waitcnt lgkmcnt(10)
v_mfma_f32_16x16x32_bf16 v[64:67], v[192:195], v[120:123], v[64:67]
ds_read_b64_tr_b16 v[184:185], v74 offset:128
ds_read_b64_tr_b16 v[186:187], v74 offset:1152
s_waitcnt lgkmcnt(10)
v_mfma_f32_16x16x32_bf16 v[64:67], v[196:199], v[124:127], v[64:67]
ds_read_b64_tr_b16 v[188:189], v74 offset:8448
ds_read_b64_tr_b16 v[190:191], v74 offset:9472
s_waitcnt lgkmcnt(10)
v_mfma_f32_16x16x32_bf16 v[64:67], v[200:203], v[128:131], v[64:67]
ds_read_b64_tr_b16 v[192:193], v75 offset:128
ds_read_b64_tr_b16 v[194:195], v75 offset:1152
s_waitcnt lgkmcnt(10)
v_mfma_f32_16x16x32_bf16 v[64:67], v[204:207], v[132:135], v[64:67]
ds_read_b64_tr_b16 v[196:197], v75 offset:8448
ds_read_b64_tr_b16 v[198:199], v75 offset:9472
s_waitcnt lgkmcnt(10)
v_mfma_f32_16x16x32_bf16 v[64:67], v[208:211], v[136:139], v[64:67]
ds_read_b64_tr_b16 v[200:201], v76 offset:128
ds_read_b64_tr_b16 v[202:203], v76 offset:1152
s_waitcnt lgkmcnt(10)
v_mfma_f32_16x16x32_bf16 v[64:67], v[212:215], v[140:143], v[64:67]
ds_read_b64_tr_b16 v[204:205], v76 offset:8448
ds_read_b64_tr_b16 v[206:207], v76 offset:9472
s_waitcnt lgkmcnt(10)
v_mfma_f32_16x16x32_bf16 v[68:71], v[184:187], v[80:83], v[68:71]
s_waitcnt lgkmcnt(8)
v_mfma_f32_16x16x32_bf16 v[68:71], v[188:191], v[84:87], v[68:71]
s_waitcnt lgkmcnt(6)
v_mfma_f32_16x16x32_bf16 v[68:71], v[192:195], v[88:91], v[68:71]
s_waitcnt lgkmcnt(4)
v_mfma_f32_16x16x32_bf16 v[68:71], v[196:199], v[92:95], v[68:71]
s_waitcnt lgkmcnt(2)
v_mfma_f32_16x16x32_bf16 v[68:71], v[200:203], v[96:99], v[68:71]
s_waitcnt lgkmcnt(0)
v_mfma_f32_16x16x32_bf16 v[68:71], v[204:207], v[100:103], v[68:71]
s_setprio 0
s_nop 7
s_branch H_CSD
H_STATS:
v_cmp_eq_u32 vcc, 0, v72
s_mov_b32 s67, 0
s_cbranch_vccz H_NOK
H_NPOLL:
buffer_load_dword v72, v36, s[40:43], 0 offen sc0 sc1
s_add_u32 s67, s67, 1
s_waitcnt vmcnt(0)
v_cmp_eq_u32 vcc, 0, v72
s_cmp_gt_u32 s67, 100000
s_cbranch_scc1 H_NOK
s_sleep 8
s_cbranch_vccnz H_NPOLL
H_NOK:
s_cmp_lg_u32 s60, 1
s_cbranch_scc1 H_NFP
s_lshl_b32 s67, s48, 3
s_add_u32 s67, s67, s49
s_lshl_b32 s67, s67, 9
s_add_u32 s67, s67, 13631488
v_lshlrev_b32 v41, 3, v1
buffer_load_dword v38, v41, s[36:39], s67 offen sc0 sc1
H_NFP:
s_cmp_lg_u32 s60, 0
s_cbranch_scc1 H_NST
v_and_b32 v41, 7, v1
v_lshlrev_b32 v42, 2, v41
v_add_u32 v42, 147344, v42
ds_read_b32 v180, v42
ds_write_b32 v28, v72 offset:8
v_mov_b32 v181, v72
v_lshlrev_b32 v41, 3, v41
s_lshl_b32 s68, s63, 4
s_add_u32 s68, s68, s64
s_lshl_b32 s68, s68, 6
s_add_u32 s68, s68, 10485760
s_mov_b64 exec, 0xff
s_waitcnt lgkmcnt(0)
buffer_store_dwordx2 v[180:181], v41, s[36:39], s68 offen sc0 sc1
s_mov_b64 exec, -1
H_NST:
s_cmp_eq_u32 s74, 0
s_cbranch_scc1 H_STD
v_mov_b32 v184, 0xff
v_lshrrev_b32 v185, 8, v72
v_lshrrev_b32 v186, 16, v72
v_lshrrev_b32 v187, 24, v72
v_bfi_b32 v64, v184, v72, v64
v_bfi_b32 v65, v184, v185, v65
v_bfi_b32 v66, v184, v186, v66
v_bfi_b32 v67, v184, v187, v67
v_bfi_b32 v68, v184, v72, v68
v_bfi_b32 v69, v184, v185, v69
v_bfi_b32 v70, v184, v186, v70
v_bfi_b32 v71, v184, v187, v71
buffer_store_dwordx4 v[64:67], v34, s[36:39], s73 offen sc0 sc1
s_nop 0
s_add_u32 s73, s73, 8192
s_mov_b32 s10, 0x003f003f
s_mov_b32 s11, s10
s_mov_b64 exec, s[10:11]
buffer_store_dwordx4 v[68:71], v34, s[36:39], s73 offen sc0 sc1
s_mov_b64 exec, -1
s_branch H_STD
MSEL:
s_getpc_b64 s[72:73]
PC:
s_sub_u32 s72, s72, PC-recurrent_scan__sliding_local_dilated__glu_gated_reglu__prompt_kernel
s_subb_u32 s73, s73, 0
v_and_b32 v18, 255, v0
v_lshlrev_b32 v18, 7, v18
v_min_u32 v18, CODE_END-recurrent_scan__sliding_local_dilated__glu_gated_reglu__prompt_kernel-4, v18
global_load_dword v19, v18, s[72:73]
v_lshlrev_b32 v18, 4, v1
s_lshl_b32 s69, s63, 4
s_add_u32 s69, s69, s64
s_lshl_b32 s69, s69, 2
s_add_u32 s69, s69, s65
s_lshl_b32 s69, s69, 11
s_waitcnt lgkmcnt(0)
s_mov_b32 s24, s4
s_mov_b32 s25, s5
s_mov_b32 s26, 2097152
s_mov_b32 s27, 0x00020000
buffer_load_dwordx4 v[240:243], v18, s[24:27], s69 offen offset:0
buffer_load_dwordx4 v[244:247], v18, s[24:27], s69 offen offset:1024
s_barrier
s_lshl_b32 s67, s2, 3
s_add_u32 s67, s67, s60
s_cmp_lg_u32 s67, 4
s_cbranch_scc1 NONON
s_memtime s[48:49]
s_memrealtime s[50:51]
s_mov_b32 s40, s20
s_mov_b32 s41, s21
s_mov_b32 s42, 256
s_mov_b32 s43, 0x00020000
s_waitcnt lgkmcnt(0)
s_mul_i32 s50, s50, 0x9e3779b1
s_xor_b32 s48, s48, s50
s_andn2_b32 s48, s48, 1
s_or_b32 s48, s48, 2
v_mov_b32 v2, 0
v_mov_b32 v3, s48
s_mov_b64 exec, 1
buffer_store_dword v3, v2, s[40:43], 0 offen sc0 sc1
s_mov_b64 exec, -1
s_nop 2
NONON:
s_bitcmp1_b32 s60, 0
s_cbranch_scc1 MP1
v_lshrrev_b32 v9, 5, v1
v_bfe_u32 v10, v1, 4, 1
v_bfe_u32 v11, v1, 2, 2
v_and_b32 v12, 3, v1
v_lshl_add_u32 v13, v9, 3, v11
v_lshlrev_b32 v14, 8, v13
v_mov_b32 v15, 8320
v_mad_u32_u24 v14, v10, v15, v14
v_lshl_add_u32 v14, v12, 3, v14
v_add_u32 v14, 18432, v14
v_xor_b32 v15, 0, v11
v_lshl_add_u32 v40, v15, 5, v14
v_xor_b32 v15, 1, v11
v_lshl_add_u32 v41, v15, 5, v14
v_xor_b32 v15, 2, v11
v_lshl_add_u32 v42, v15, 5, v14
v_mul_u32_u24 v15, 192, v13
v_lshl_add_u32 v15, v10, 5, v15
v_lshl_add_u32 v15, v12, 3, v15
v_add_u32 v43, 34944, v15
v_and_b32 v15, 31, v1
v_bfe_u32 v16, v1, 1, 3
v_xor_b32 v16, v16, v9
s_lshr_b32 s70, s65, 1
s_lshl_b32 s70, s70, 6
s_add_u32 s70, s70, 16
v_add_u32 v15, s70, v15
v_lshlrev_b32 v15, 7, v15
v_lshl_add_u32 v24, v16, 4, v15
v_mov_b32 v2, v40
v_add_u32 v6, 63744, v40
v_mov_b32 v3, v41
v_add_u32 v7, 63744, v41
v_mov_b32 v4, v42
v_add_u32 v8, 63744, v42
v_mov_b32 v5, v43
v_add_u32 v9, 63744, v43
s_mov_b32 s53, 63744
s_mov_b32 s54, 127488
s_mov_b32 s55, 0
s_mov_b32 s58, 0
s_mov_b32 s57, 2
v_add_u32 v20, s53, v24
v_xor_b32 v21, 32, v20
v_xor_b32 v22, 64, v20
v_xor_b32 v23, 96, v20
v_mov_b32 v11, 147408
s_lshl_b32 s67, s60, 2
s_add_u32 s67, s67, 147424
v_mov_b32 v13, s67
v_mov_b32 v12, 0
v_mov_b64 v[64:65], 0
v_mov_b64 v[66:67], 0
v_mov_b64 v[68:69], 0
v_mov_b64 v[70:71], 0
v_mov_b64 v[72:73], 0
v_mov_b64 v[74:75], 0
v_mov_b64 v[76:77], 0
v_mov_b64 v[78:79], 0
v_mov_b64 v[80:81], 0
v_mov_b64 v[82:83], 0
v_mov_b64 v[84:85], 0
v_mov_b64 v[86:87], 0
v_mov_b64 v[88:89], 0
v_mov_b64 v[90:91], 0
v_mov_b64 v[92:93], 0
v_mov_b64 v[94:95], 0
v_mov_b64 v[96:97], 0
v_mov_b64 v[98:99], 0
v_mov_b64 v[100:101], 0
v_mov_b64 v[102:103], 0
v_mov_b64 v[104:105], 0
v_mov_b64 v[106:107], 0
v_mov_b64 v[108:109], 0
v_mov_b64 v[110:111], 0
v_mov_b64 v[112:113], 0
v_mov_b64 v[114:115], 0
v_mov_b64 v[116:117], 0
v_mov_b64 v[118:119], 0
v_mov_b64 v[120:121], 0
v_mov_b64 v[122:123], 0
v_mov_b64 v[124:125], 0
v_mov_b64 v[126:127], 0
v_mov_b64 v[128:129], 0
v_mov_b64 v[130:131], 0
v_mov_b64 v[132:133], 0
v_mov_b64 v[134:135], 0
v_mov_b64 v[136:137], 0
v_mov_b64 v[138:139], 0
v_mov_b64 v[140:141], 0
v_mov_b64 v[142:143], 0
v_mov_b64 v[144:145], 0
v_mov_b64 v[146:147], 0
v_mov_b64 v[148:149], 0
v_mov_b64 v[150:151], 0
v_mov_b64 v[152:153], 0
v_mov_b64 v[154:155], 0
v_mov_b64 v[156:157], 0
v_mov_b64 v[158:159], 0
v_mov_b64 v[160:161], 0
v_mov_b64 v[162:163], 0
v_mov_b64 v[164:165], 0
v_mov_b64 v[166:167], 0
v_mov_b64 v[168:169], 0
v_mov_b64 v[170:171], 0
v_mov_b64 v[172:173], 0
v_mov_b64 v[174:175], 0
v_mov_b64 v[176:177], 0
v_mov_b64 v[178:179], 0
v_mov_b64 v[180:181], 0
v_mov_b64 v[182:183], 0
v_mov_b64 v[184:185], 0
v_mov_b64 v[186:187], 0
v_mov_b64 v[188:189], 0
v_mov_b64 v[190:191], 0
v_mov_b64 v[192:193], 0
v_mov_b64 v[194:195], 0
v_mov_b64 v[196:197], 0
v_mov_b64 v[198:199], 0
v_mov_b64 v[200:201], 0
v_mov_b64 v[202:203], 0
v_mov_b64 v[204:205], 0
v_mov_b64 v[206:207], 0
v_mov_b64 v[208:209], 0
v_mov_b64 v[210:211], 0
v_mov_b64 v[212:213], 0
v_mov_b64 v[214:215], 0
v_mov_b64 v[216:217], 0
v_mov_b64 v[218:219], 0
v_mov_b64 v[220:221], 0
v_mov_b64 v[222:223], 0
v_mov_b64 v[224:225], 0
v_mov_b64 v[226:227], 0
v_mov_b64 v[228:229], 0
v_mov_b64 v[230:231], 0
v_mov_b64 v[232:233], 0
v_mov_b64 v[234:235], 0
v_mov_b64 v[236:237], 0
v_mov_b64 v[238:239], 0
s_mov_b32 s36, s22
s_mov_b32 s37, s23
s_mov_b32 s38, 67108864
s_mov_b32 s39, 0x00020000
s_lshl_b32 s67, s63, 7
s_lshr_b32 s68, s65, 1
s_lshl_b32 s68, s68, 6
s_add_u32 s67, s67, s68
s_lshl_b32 s67, s67, 3
s_add_u32 s56, s67, 10485760
v_and_b32 v25, 31, v1
v_lshlrev_b32 v25, 3, v25
s_and_b32 s67, s63, 7
s_mov_b32 s31, 0x00020000
s_mov_b32 s51, 0x1000
s_cmp_eq_u32 s60, 4
s_cselect_b32 s28, s12, s14
s_cselect_b32 s29, s13, s15
s_cmp_lt_u32 s64, 14
s_cselect_b32 s30, 1835008, 0
v_lshrrev_b32 v14, 1, v1
v_mul_u32_u24 v14, 3584, v14
v_and_b32 v15, 1, v1
v_lshl_add_u32 v14, v15, 7, v14
s_mov_b32 s59, 1835008
s_mov_b32 s71, 1835008
s_mul_i32 s49, s63, 114688
s_lshl_b32 s68, s64, 8
s_add_u32 s49, s49, s68
s_mov_b32 s50, 917504
s_add_u32 s48, s67, 0
s_sub_u32 s67, s67, 4
s_cbranch_scc1 M0_PFI
M0_PFW:
s_sub_u32 s67, s67, 1
s_cbranch_scc1 M0_PFI
s_sleep 8
s_branch M0_PFW
M0_PFI:
buffer_load_dword v15, v14, s[28:31], s49 offen
M0_PFSK:
s_add_u32 s49, s49, s50
s_cmp_ge_u32 s49, s59
s_cselect_b32 s67, s71, 0
s_sub_u32 s49, s49, s67
s_waitcnt vmcnt(1)
v_lshlrev_b32 v32, 16, v240
v_and_b32 v33, 0xffff0000, v240
v_lshlrev_b32 v34, 16, v241
v_and_b32 v35, 0xffff0000, v241
v_lshlrev_b32 v36, 16, v242
v_and_b32 v37, 0xffff0000, v242
v_lshlrev_b32 v38, 16, v243
v_and_b32 v39, 0xffff0000, v243
v_lshlrev_b32 v40, 16, v244
v_and_b32 v41, 0xffff0000, v244
v_lshlrev_b32 v42, 16, v245
v_and_b32 v43, 0xffff0000, v245
v_lshlrev_b32 v44, 16, v246
v_and_b32 v45, 0xffff0000, v246
v_lshlrev_b32 v46, 16, v247
v_and_b32 v47, 0xffff0000, v247
v_add_f32 v48, v32, v33
v_mul_f32 v49, v32, v32
v_add_f32 v50, v40, v41
v_mul_f32 v51, v40, v40
v_fmac_f32 v49, v33, v33
v_fmac_f32 v51, v41, v41
v_add_f32 v48, v48, v34
v_fmac_f32 v49, v34, v34
v_add_f32 v50, v50, v42
v_fmac_f32 v51, v42, v42
v_add_f32 v48, v48, v35
v_fmac_f32 v49, v35, v35
v_add_f32 v50, v50, v43
v_fmac_f32 v51, v43, v43
v_add_f32 v48, v48, v36
v_fmac_f32 v49, v36, v36
v_add_f32 v50, v50, v44
v_fmac_f32 v51, v44, v44
v_add_f32 v48, v48, v37
v_fmac_f32 v49, v37, v37
v_add_f32 v50, v50, v45
v_fmac_f32 v51, v45, v45
v_add_f32 v48, v48, v38
v_fmac_f32 v49, v38, v38
v_add_f32 v50, v50, v46
v_fmac_f32 v51, v46, v46
v_add_f32 v48, v48, v39
v_fmac_f32 v49, v39, v39
v_add_f32 v50, v50, v47
v_fmac_f32 v51, v47, v47
v_add_f32_dpp v48, v48, v48 row_ror:8 row_mask:0xf bank_mask:0xf
v_add_f32_dpp v49, v49, v49 row_ror:8 row_mask:0xf bank_mask:0xf
v_add_f32_dpp v50, v50, v50 row_ror:8 row_mask:0xf bank_mask:0xf
v_add_f32_dpp v51, v51, v51 row_ror:8 row_mask:0xf bank_mask:0xf
v_add_f32_dpp v48, v48, v48 row_ror:4 row_mask:0xf bank_mask:0xf
v_add_f32_dpp v49, v49, v49 row_ror:4 row_mask:0xf bank_mask:0xf
v_add_f32_dpp v50, v50, v50 row_ror:4 row_mask:0xf bank_mask:0xf
v_add_f32_dpp v51, v51, v51 row_ror:4 row_mask:0xf bank_mask:0xf
v_add_f32_dpp v48, v48, v48 row_ror:2 row_mask:0xf bank_mask:0xf
v_add_f32_dpp v49, v49, v49 row_ror:2 row_mask:0xf bank_mask:0xf
v_add_f32_dpp v50, v50, v50 row_ror:2 row_mask:0xf bank_mask:0xf
v_add_f32_dpp v51, v51, v51 row_ror:2 row_mask:0xf bank_mask:0xf
v_add_f32_dpp v48, v48, v48 row_ror:1 row_mask:0xf bank_mask:0xf
v_add_f32_dpp v49, v49, v49 row_ror:1 row_mask:0xf bank_mask:0xf
v_add_f32_dpp v50, v50, v50 row_ror:1 row_mask:0xf bank_mask:0xf
v_add_f32_dpp v51, v51, v51 row_ror:1 row_mask:0xf bank_mask:0xf
v_mov_b32 v52, v48
v_mov_b32 v53, v49
v_mov_b32 v54, v50
v_mov_b32 v55, v51
v_permlane16_swap_b32 v48, v52
v_permlane16_swap_b32 v49, v53
v_permlane16_swap_b32 v50, v54
v_permlane16_swap_b32 v51, v55
v_add_f32 v48, v48, v52
v_add_f32 v49, v49, v53
v_add_f32 v50, v50, v54
v_add_f32 v51, v51, v55
v_mov_b32 v52, v48
v_mov_b32 v53, v49
v_mov_b32 v54, v50
v_mov_b32 v55, v51
v_permlane32_swap_b32 v48, v52
v_permlane32_swap_b32 v49, v53
v_permlane32_swap_b32 v50, v54
v_permlane32_swap_b32 v51, v55
v_add_f32 v48, v48, v52
v_add_f32 v49, v49, v53
v_add_f32 v50, v50, v54
v_add_f32 v51, v51, v55
v_mul_f32 v52, 0x3b000000, v48
v_mul_f32 v49, 0x3b000000, v49
v_fma_f32 v49, -v52, v52, v49
v_max_f32 v49, 0, v49
v_cvt_pk_bf16_f32 v56, v52, v52
v_lshlrev_b32 v52, 16, v56
v_cvt_pk_bf16_f32 v56, v49, v49
v_lshlrev_b32 v49, 16, v56
v_add_f32 v49, 0x3727c5ac, v49
v_cvt_pk_bf16_f32 v56, v49, v49
v_lshlrev_b32 v49, 16, v56
v_sqrt_f32 v49, v49
s_nop 0
v_cvt_pk_bf16_f32 v56, v49, v49
v_lshlrev_b32 v49, 16, v56
v_mul_f32 v53, 0x3b000000, v50
v_mul_f32 v51, 0x3b000000, v51
v_fma_f32 v51, -v53, v53, v51
v_max_f32 v51, 0, v51
v_cvt_pk_bf16_f32 v57, v53, v53
v_lshlrev_b32 v53, 16, v57
v_cvt_pk_bf16_f32 v57, v51, v51
v_lshlrev_b32 v51, 16, v57
v_add_f32 v51, 0x3727c5ac, v51
v_cvt_pk_bf16_f32 v57, v51, v51
v_lshlrev_b32 v51, 16, v57
v_sqrt_f32 v51, v51
s_nop 0
v_cvt_pk_bf16_f32 v57, v51, v51
v_lshlrev_b32 v51, 16, v57
v_lshrrev_b32 v49, 16, v49
v_or_b32 v52, v52, v49
v_lshrrev_b32 v51, 16, v51
v_or_b32 v53, v53, v51
s_lshl_b32 s67, s65, 3
s_add_u32 s67, s67, 147344
v_mov_b32 v56, s67
s_mov_b64 exec, 1
ds_write_b64 v56, v[52:53]
s_mov_b64 exec, -1
s_setprio 3
M0_S0:
s_mov_b32 s67, 0
M0_S0L:
s_sleep 1
ds_read_b32 v10, v11
s_add_u32 s67, s67, 1
s_waitcnt lgkmcnt(0)
v_cmp_gt_u32 vcc, s57, v10
s_cmp_gt_u32 s67, 200000
s_cbranch_scc1 M0_GO
s_cbranch_vccnz M0_S0L
s_branch M0_GO
M0_GO:
s_mov_b32 s57, 3
ds_read_b64_tr_b16 v[32:33], v5 offset:0
ds_read_b64_tr_b16 v[34:35], v5 offset:768
ds_read_b64_tr_b16 v[36:37], v5 offset:64
ds_read_b64_tr_b16 v[38:39], v5 offset:832
ds_read_b128 v[240:243], v20 offset:0
ds_read_b64_tr_b16 v[40:41], v5 offset:128
ds_read_b64_tr_b16 v[42:43], v5 offset:896
ds_read_b128 v[244:247], v20 offset:4096
ds_read_b64_tr_b16 v[44:45], v2 offset:0
ds_read_b64_tr_b16 v[46:47], v2 offset:1024
ds_read_b64_tr_b16 v[48:49], v3 offset:0
ds_read_b64_tr_b16 v[50:51], v3 offset:1024
ds_read_b64_tr_b16 v[52:53], v4 offset:0
ds_read_b64_tr_b16 v[54:55], v4 offset:1024
ds_read_b64_tr_b16 v[56:57], v5 offset:3072
ds_read_b64_tr_b16 v[58:59], v5 offset:3840
M0_LOOP:
s_waitcnt lgkmcnt(11)
v_mfma_f32_32x32x16_bf16 v[64:79], v[32:35], v[240:243], v[64:79]
ds_read_b128 v[248:251], v21 offset:0
ds_read_b64_tr_b16 v[60:61], v5 offset:3136
ds_read_b64_tr_b16 v[62:63], v5 offset:3904
s_waitcnt lgkmcnt(11)
v_mfma_f32_32x32x16_bf16 v[80:95], v[32:35], v[244:247], v[80:95]
ds_read_b128 v[252:255], v21 offset:4096
v_mfma_f32_32x32x16_bf16 v[96:111], v[36:39], v[240:243], v[96:111]
s_sub_u32 s48, s48, 1
s_cbranch_scc1 M0_PF0
M0_PR0:
ds_read_b64_tr_b16 v[32:33], v5 offset:3200
ds_read_b64_tr_b16 v[34:35], v5 offset:3968
v_mfma_f32_32x32x16_bf16 v[112:127], v[36:39], v[244:247], v[112:127]
v_mfma_f32_32x32x16_bf16 v[128:143], v[40:43], v[240:243], v[128:143]
ds_read_b32 v10, v11
ds_read_b64_tr_b16 v[36:37], v2 offset:4096
ds_read_b64_tr_b16 v[38:39], v2 offset:5120
v_mfma_f32_32x32x16_bf16 v[144:159], v[40:43], v[244:247], v[144:159]
s_waitcnt lgkmcnt(15)
v_mfma_f32_32x32x16_bf16 v[160:175], v[44:47], v[240:243], v[160:175]
ds_read_b64_tr_b16 v[40:41], v3 offset:4096
ds_read_b64_tr_b16 v[42:43], v3 offset:5120
v_mfma_f32_32x32x16_bf16 v[176:191], v[44:47], v[244:247], v[176:191]
s_waitcnt lgkmcnt(15)
v_mfma_f32_32x32x16_bf16 v[192:207], v[48:51], v[240:243], v[192:207]
s_waitcnt lgkmcnt(4)
v_cmp_gt_u32 vcc, s57, v10
v_add_u32 v12, 1, v12
ds_read_b64_tr_b16 v[44:45], v4 offset:4096
ds_read_b64_tr_b16 v[46:47], v4 offset:5120
v_mfma_f32_32x32x16_bf16 v[208:223], v[48:51], v[244:247], v[208:223]
s_mov_b64 exec, 1
ds_write_b32 v13, v12
s_mov_b64 exec, -1
s_cbranch_vccnz M0_SL0
M0_RT0:
ds_read_b64_tr_b16 v[48:49], v5 offset:22656
ds_read_b64_tr_b16 v[50:51], v5 offset:23424
v_mfma_f32_32x32x16_bf16 v[224:239], v[52:55], v[240:243], v[224:239]
s_add_u32 s57, s57, 1
s_min_u32 s57, s57, 17
v_mfma_f32_32x32x16_bf16 v[64:79], v[56:59], v[248:251], v[64:79]
ds_read_b64_tr_b16 v[52:53], v5 offset:22720
ds_read_b64_tr_b16 v[54:55], v5 offset:23488
v_mfma_f32_32x32x16_bf16 v[80:95], v[56:59], v[252:255], v[80:95]
v_mfma_f32_32x32x16_bf16 v[96:111], v[60:63], v[248:251], v[96:111]
ds_read_b128 v[240:243], v22 offset:0
ds_read_b64_tr_b16 v[56:57], v5 offset:22784
ds_read_b64_tr_b16 v[58:59], v5 offset:23552
v_mfma_f32_32x32x16_bf16 v[112:127], v[60:63], v[252:255], v[112:127]
ds_read_b128 v[244:247], v22 offset:4096
v_mfma_f32_32x32x16_bf16 v[128:143], v[32:35], v[248:251], v[128:143]
ds_read_b64_tr_b16 v[60:61], v2 offset:22656
ds_read_b64_tr_b16 v[62:63], v2 offset:23680
v_mfma_f32_32x32x16_bf16 v[144:159], v[32:35], v[252:255], v[144:159]
s_waitcnt lgkmcnt(15)
v_mfma_f32_32x32x16_bf16 v[160:175], v[36:39], v[248:251], v[160:175]
ds_read_b64_tr_b16 v[32:33], v3 offset:22656
ds_read_b64_tr_b16 v[34:35], v3 offset:23680
v_mfma_f32_32x32x16_bf16 v[176:191], v[36:39], v[252:255], v[176:191]
s_waitcnt lgkmcnt(15)
v_mfma_f32_32x32x16_bf16 v[192:207], v[40:43], v[248:251], v[192:207]
ds_read_b64_tr_b16 v[36:37], v4 offset:22656
ds_read_b64_tr_b16 v[38:39], v4 offset:23680
v_mfma_f32_32x32x16_bf16 v[208:223], v[40:43], v[252:255], v[208:223]
ds_read_b64_tr_b16 v[40:41], v5 offset:25728
ds_read_b64_tr_b16 v[42:43], v5 offset:26496
s_waitcnt lgkmcnt(15)
v_mfma_f32_32x32x16_bf16 v[224:239], v[44:47], v[248:251], v[224:239]
s_waitcnt lgkmcnt(11)
v_mfma_f32_32x32x16_bf16 v[64:79], v[48:51], v[240:243], v[64:79]
ds_read_b128 v[248:251], v23 offset:0
ds_read_b64_tr_b16 v[44:45], v5 offset:25792
ds_read_b64_tr_b16 v[46:47], v5 offset:26560
s_waitcnt lgkmcnt(11)
v_mfma_f32_32x32x16_bf16 v[80:95], v[48:51], v[244:247], v[80:95]
ds_read_b128 v[252:255], v23 offset:4096
v_mfma_f32_32x32x16_bf16 v[96:111], v[52:55], v[240:243], v[96:111]
s_sub_u32 s48, s48, 1
s_cbranch_scc1 M0_PF1
M0_PR1:
ds_read_b64_tr_b16 v[48:49], v5 offset:25856
ds_read_b64_tr_b16 v[50:51], v5 offset:26624
v_mfma_f32_32x32x16_bf16 v[112:127], v[52:55], v[244:247], v[112:127]
v_mfma_f32_32x32x16_bf16 v[128:143], v[56:59], v[240:243], v[128:143]
ds_read_b32 v10, v11
ds_read_b64_tr_b16 v[52:53], v2 offset:26752
ds_read_b64_tr_b16 v[54:55], v2 offset:27776
v_mfma_f32_32x32x16_bf16 v[144:159], v[56:59], v[244:247], v[144:159]
s_waitcnt lgkmcnt(15)
v_mfma_f32_32x32x16_bf16 v[160:175], v[60:63], v[240:243], v[160:175]
ds_read_b64_tr_b16 v[56:57], v3 offset:26752
ds_read_b64_tr_b16 v[58:59], v3 offset:27776
v_mfma_f32_32x32x16_bf16 v[176:191], v[60:63], v[244:247], v[176:191]
s_waitcnt lgkmcnt(15)
v_mfma_f32_32x32x16_bf16 v[192:207], v[32:35], v[240:243], v[192:207]
s_waitcnt lgkmcnt(4)
v_cmp_gt_u32 vcc, s57, v10
v_add_u32 v12, 1, v12
ds_read_b64_tr_b16 v[60:61], v4 offset:26752
ds_read_b64_tr_b16 v[62:63], v4 offset:27776
v_mfma_f32_32x32x16_bf16 v[208:223], v[32:35], v[244:247], v[208:223]
s_mov_b64 exec, 1
ds_write_b32 v13, v12
s_mov_b64 exec, -1
s_cbranch_vccnz M0_SL1
M0_RT1:
ds_read_b64_tr_b16 v[32:33], v9 offset:0
ds_read_b64_tr_b16 v[34:35], v9 offset:768
v_mfma_f32_32x32x16_bf16 v[224:239], v[36:39], v[240:243], v[224:239]
s_add_u32 s57, s57, 1
s_min_u32 s57, s57, 17
v_mfma_f32_32x32x16_bf16 v[64:79], v[40:43], v[248:251], v[64:79]
s_mov_b32 s70, s53
s_mov_b32 s53, s54
s_mov_b32 s54, s55
s_mov_b32 s55, s70
ds_read_b64_tr_b16 v[36:37], v9 offset:64
ds_read_b64_tr_b16 v[38:39], v9 offset:832
v_mfma_f32_32x32x16_bf16 v[80:95], v[40:43], v[252:255], v[80:95]
v_add_u32 v20, s53, v24
v_xor_b32 v21, 32, v20
v_xor_b32 v22, 64, v20
v_xor_b32 v23, 96, v20
v_mfma_f32_32x32x16_bf16 v[96:111], v[44:47], v[248:251], v[96:111]
ds_read_b128 v[240:243], v20 offset:0
ds_read_b64_tr_b16 v[40:41], v9 offset:128
ds_read_b64_tr_b16 v[42:43], v9 offset:896
s_cmp_lg_u32 s58, 3
s_cbranch_scc1 M0_NOST
buffer_load_dwordx2 v[26:27], v25, s[36:39], s56 offen offset:0 sc0 sc1
buffer_load_dwordx2 v[28:29], v25, s[36:39], s56 offen offset:256 sc0 sc1
M0_NOST:
v_mfma_f32_32x32x16_bf16 v[112:127], v[44:47], v[252:255], v[112:127]
ds_read_b128 v[244:247], v20 offset:4096
v_mfma_f32_32x32x16_bf16 v[128:143], v[48:51], v[248:251], v[128:143]
ds_read_b64_tr_b16 v[44:45], v6 offset:0
ds_read_b64_tr_b16 v[46:47], v6 offset:1024
v_mfma_f32_32x32x16_bf16 v[144:159], v[48:51], v[252:255], v[144:159]
s_waitcnt lgkmcnt(15)
v_mfma_f32_32x32x16_bf16 v[160:175], v[52:55], v[248:251], v[160:175]
ds_read_b64_tr_b16 v[48:49], v7 offset:0
ds_read_b64_tr_b16 v[50:51], v7 offset:1024
v_mfma_f32_32x32x16_bf16 v[176:191], v[52:55], v[252:255], v[176:191]
s_waitcnt lgkmcnt(15)
v_mfma_f32_32x32x16_bf16 v[192:207], v[56:59], v[248:251], v[192:207]
ds_read_b64_tr_b16 v[52:53], v8 offset:0
ds_read_b64_tr_b16 v[54:55], v8 offset:1024
v_mfma_f32_32x32x16_bf16 v[208:223], v[56:59], v[252:255], v[208:223]
ds_read_b64_tr_b16 v[56:57], v9 offset:3072
ds_read_b64_tr_b16 v[58:59], v9 offset:3840
s_waitcnt lgkmcnt(15)
v_mfma_f32_32x32x16_bf16 v[224:239], v[60:63], v[248:251], v[224:239]
s_waitcnt lgkmcnt(11)
v_mfma_f32_32x32x16_bf16 v[64:79], v[32:35], v[240:243], v[64:79]
ds_read_b128 v[248:251], v21 offset:0
ds_read_b64_tr_b16 v[60:61], v9 offset:3136
ds_read_b64_tr_b16 v[62:63], v9 offset:3904
s_waitcnt lgkmcnt(11)
v_mfma_f32_32x32x16_bf16 v[80:95], v[32:35], v[244:247], v[80:95]
ds_read_b128 v[252:255], v21 offset:4096
v_mfma_f32_32x32x16_bf16 v[96:111], v[36:39], v[240:243], v[96:111]
s_sub_u32 s48, s48, 1
s_cbranch_scc1 M0_PF2
M0_PR2:
ds_read_b64_tr_b16 v[32:33], v9 offset:3200
ds_read_b64_tr_b16 v[34:35], v9 offset:3968
v_mfma_f32_32x32x16_bf16 v[112:127], v[36:39], v[244:247], v[112:127]
v_mfma_f32_32x32x16_bf16 v[128:143], v[40:43], v[240:243], v[128:143]
ds_read_b32 v10, v11
ds_read_b64_tr_b16 v[36:37], v6 offset:4096
ds_read_b64_tr_b16 v[38:39], v6 offset:5120
v_mfma_f32_32x32x16_bf16 v[144:159], v[40:43], v[244:247], v[144:159]
s_waitcnt lgkmcnt(15)
v_mfma_f32_32x32x16_bf16 v[160:175], v[44:47], v[240:243], v[160:175]
ds_read_b64_tr_b16 v[40:41], v7 offset:4096
ds_read_b64_tr_b16 v[42:43], v7 offset:5120
v_mfma_f32_32x32x16_bf16 v[176:191], v[44:47], v[244:247], v[176:191]
s_waitcnt lgkmcnt(15)
v_mfma_f32_32x32x16_bf16 v[192:207], v[48:51], v[240:243], v[192:207]
s_waitcnt lgkmcnt(4)
v_cmp_gt_u32 vcc, s57, v10
v_add_u32 v12, 1, v12
ds_read_b64_tr_b16 v[44:45], v8 offset:4096
ds_read_b64_tr_b16 v[46:47], v8 offset:5120
v_mfma_f32_32x32x16_bf16 v[208:223], v[48:51], v[244:247], v[208:223]
s_mov_b64 exec, 1
ds_write_b32 v13, v12
s_mov_b64 exec, -1
s_cbranch_vccnz M0_SL2
M0_RT2:
ds_read_b64_tr_b16 v[48:49], v9 offset:22656
ds_read_b64_tr_b16 v[50:51], v9 offset:23424
v_mfma_f32_32x32x16_bf16 v[224:239], v[52:55], v[240:243], v[224:239]
s_add_u32 s57, s57, 1
s_min_u32 s57, s57, 17
v_mfma_f32_32x32x16_bf16 v[64:79], v[56:59], v[248:251], v[64:79]
ds_read_b64_tr_b16 v[52:53], v9 offset:22720
ds_read_b64_tr_b16 v[54:55], v9 offset:23488
v_mfma_f32_32x32x16_bf16 v[80:95], v[56:59], v[252:255], v[80:95]
v_mfma_f32_32x32x16_bf16 v[96:111], v[60:63], v[248:251], v[96:111]
ds_read_b128 v[240:243], v22 offset:0
ds_read_b64_tr_b16 v[56:57], v9 offset:22784
ds_read_b64_tr_b16 v[58:59], v9 offset:23552
v_mfma_f32_32x32x16_bf16 v[112:127], v[60:63], v[252:255], v[112:127]
ds_read_b128 v[244:247], v22 offset:4096
v_mfma_f32_32x32x16_bf16 v[128:143], v[32:35], v[248:251], v[128:143]
ds_read_b64_tr_b16 v[60:61], v6 offset:22656
ds_read_b64_tr_b16 v[62:63], v6 offset:23680
v_mfma_f32_32x32x16_bf16 v[144:159], v[32:35], v[252:255], v[144:159]
s_waitcnt lgkmcnt(15)
v_mfma_f32_32x32x16_bf16 v[160:175], v[36:39], v[248:251], v[160:175]
ds_read_b64_tr_b16 v[32:33], v7 offset:22656
ds_read_b64_tr_b16 v[34:35], v7 offset:23680
v_mfma_f32_32x32x16_bf16 v[176:191], v[36:39], v[252:255], v[176:191]
s_waitcnt lgkmcnt(15)
v_mfma_f32_32x32x16_bf16 v[192:207], v[40:43], v[248:251], v[192:207]
ds_read_b64_tr_b16 v[36:37], v8 offset:22656
ds_read_b64_tr_b16 v[38:39], v8 offset:23680
v_mfma_f32_32x32x16_bf16 v[208:223], v[40:43], v[252:255], v[208:223]
ds_read_b64_tr_b16 v[40:41], v9 offset:25728
ds_read_b64_tr_b16 v[42:43], v9 offset:26496
s_waitcnt lgkmcnt(15)
v_mfma_f32_32x32x16_bf16 v[224:239], v[44:47], v[248:251], v[224:239]
s_waitcnt lgkmcnt(11)
v_mfma_f32_32x32x16_bf16 v[64:79], v[48:51], v[240:243], v[64:79]
ds_read_b128 v[248:251], v23 offset:0
ds_read_b64_tr_b16 v[44:45], v9 offset:25792
ds_read_b64_tr_b16 v[46:47], v9 offset:26560
s_waitcnt lgkmcnt(11)
v_mfma_f32_32x32x16_bf16 v[80:95], v[48:51], v[244:247], v[80:95]
ds_read_b128 v[252:255], v23 offset:4096
v_mfma_f32_32x32x16_bf16 v[96:111], v[52:55], v[240:243], v[96:111]
s_sub_u32 s48, s48, 1
s_cbranch_scc1 M0_PF3
M0_PR3:
ds_read_b64_tr_b16 v[48:49], v9 offset:25856
ds_read_b64_tr_b16 v[50:51], v9 offset:26624
v_mfma_f32_32x32x16_bf16 v[112:127], v[52:55], v[244:247], v[112:127]
v_mfma_f32_32x32x16_bf16 v[128:143], v[56:59], v[240:243], v[128:143]
ds_read_b32 v10, v11
ds_read_b64_tr_b16 v[52:53], v6 offset:26752
ds_read_b64_tr_b16 v[54:55], v6 offset:27776
v_mfma_f32_32x32x16_bf16 v[144:159], v[56:59], v[244:247], v[144:159]
s_waitcnt lgkmcnt(15)
v_mfma_f32_32x32x16_bf16 v[160:175], v[60:63], v[240:243], v[160:175]
ds_read_b64_tr_b16 v[56:57], v7 offset:26752
ds_read_b64_tr_b16 v[58:59], v7 offset:27776
v_mfma_f32_32x32x16_bf16 v[176:191], v[60:63], v[244:247], v[176:191]
s_waitcnt lgkmcnt(15)
v_mfma_f32_32x32x16_bf16 v[192:207], v[32:35], v[240:243], v[192:207]
s_waitcnt lgkmcnt(4)
v_cmp_gt_u32 vcc, s57, v10
v_add_u32 v12, 1, v12
ds_read_b64_tr_b16 v[60:61], v8 offset:26752
ds_read_b64_tr_b16 v[62:63], v8 offset:27776
v_mfma_f32_32x32x16_bf16 v[208:223], v[32:35], v[244:247], v[208:223]
s_mov_b64 exec, 1
ds_write_b32 v13, v12
s_mov_b64 exec, -1
s_cbranch_vccnz M0_SL3
M0_RT3:
ds_read_b64_tr_b16 v[32:33], v5 offset:0
ds_read_b64_tr_b16 v[34:35], v5 offset:768
v_mfma_f32_32x32x16_bf16 v[224:239], v[36:39], v[240:243], v[224:239]
s_add_u32 s57, s57, 1
s_min_u32 s57, s57, 17
v_mfma_f32_32x32x16_bf16 v[64:79], v[40:43], v[248:251], v[64:79]
s_mov_b32 s70, s53
s_mov_b32 s53, s54
s_mov_b32 s54, s55
s_mov_b32 s55, s70
ds_read_b64_tr_b16 v[36:37], v5 offset:64
ds_read_b64_tr_b16 v[38:39], v5 offset:832
v_mfma_f32_32x32x16_bf16 v[80:95], v[40:43], v[252:255], v[80:95]
v_add_u32 v20, s53, v24
v_xor_b32 v21, 32, v20
v_xor_b32 v22, 64, v20
v_xor_b32 v23, 96, v20
v_mfma_f32_32x32x16_bf16 v[96:111], v[44:47], v[248:251], v[96:111]
ds_read_b128 v[240:243], v20 offset:0
ds_read_b64_tr_b16 v[40:41], v5 offset:128
ds_read_b64_tr_b16 v[42:43], v5 offset:896
v_mfma_f32_32x32x16_bf16 v[112:127], v[44:47], v[252:255], v[112:127]
ds_read_b128 v[244:247], v20 offset:4096
v_mfma_f32_32x32x16_bf16 v[128:143], v[48:51], v[248:251], v[128:143]
ds_read_b64_tr_b16 v[44:45], v2 offset:0
ds_read_b64_tr_b16 v[46:47], v2 offset:1024
v_mfma_f32_32x32x16_bf16 v[144:159], v[48:51], v[252:255], v[144:159]
s_waitcnt lgkmcnt(15)
v_mfma_f32_32x32x16_bf16 v[160:175], v[52:55], v[248:251], v[160:175]
ds_read_b64_tr_b16 v[48:49], v3 offset:0
ds_read_b64_tr_b16 v[50:51], v3 offset:1024
v_mfma_f32_32x32x16_bf16 v[176:191], v[52:55], v[252:255], v[176:191]
s_waitcnt lgkmcnt(15)
v_mfma_f32_32x32x16_bf16 v[192:207], v[56:59], v[248:251], v[192:207]
ds_read_b64_tr_b16 v[52:53], v4 offset:0
ds_read_b64_tr_b16 v[54:55], v4 offset:1024
v_mfma_f32_32x32x16_bf16 v[208:223], v[56:59], v[252:255], v[208:223]
ds_read_b64_tr_b16 v[56:57], v5 offset:3072
ds_read_b64_tr_b16 v[58:59], v5 offset:3840
s_waitcnt lgkmcnt(15)
v_mfma_f32_32x32x16_bf16 v[224:239], v[60:63], v[248:251], v[224:239]
s_add_u32 s58, s58, 1
s_cmp_lt_u32 s58, 4
s_cbranch_scc1 M0_LOOP
s_mov_b32 s24, s4
s_mov_b32 s25, s5
s_mov_b32 s26, 2097152
s_mov_b32 s27, 0x00020000
s_lshl_b32 s48, s61, 2
s_and_b32 s67, s62, 3
s_add_u32 s48, s48, s67
s_lshr_b32 s49, s62, 2
s_mul_i32 s52, s60, 18
s_sub_i32 s67, s60, 2
s_max_i32 s67, s67, 0
s_min_i32 s67, s67, 2
s_lshl_b32 s67, s67, 1
s_add_u32 s52, s52, s67
s_lshr_b32 s67, s60, 1
s_cmp_eq_u32 s67, 1
s_cselect_b32 s51, 20, 18
s_add_u32 s74, s52, 32
s_mov_b32 s59, 0x02020202
s_sub_u32 s67, s60, 6
s_lshl_b32 s67, s67, 4
s_mov_b32 s46, 1835008
s_cmp_ge_u32 s60, 6
s_cselect_b32 s52, s67, s52
s_cselect_b32 s51, 16, s51
s_cselect_b32 s74, s67, s74
s_cselect_b32 s59, 0x04040404, s59
s_cselect_b32 s44, s8, s16
s_cselect_b32 s45, s9, s17
s_cselect_b32 s46, 524288, s46
s_mov_b32 s47, 0x00020000
s_lshl_b32 s73, s52, 14
s_lshl_b32 s67, s49, 7
s_add_u32 s73, s73, s67
s_lshl_b32 s69, s60, 11
s_mul_i32 s67, s48, 288
s_add_u32 s74, s74, s67
s_lshl_b32 s74, s74, 10
s_add_u32 s73, s73, 131072
v_and_b32 v9, 31, v1
v_lshlrev_b32 v9, 2, v9
v_add_u32 v9, 145920, v9
v_lshlrev_b32 v8, 4, v1
s_waitcnt lgkmcnt(0)
v_mov_b64 v[32:33], 0
v_mov_b64 v[34:35], 0
v_mov_b64 v[36:37], 0
v_mov_b64 v[38:39], 0
v_mov_b64 v[40:41], 0
v_mov_b64 v[42:43], 0
v_mov_b64 v[44:45], 0
v_mov_b64 v[46:47], 0
v_mov_b64 v[240:241], 0
v_mov_b64 v[242:243], 0
v_mov_b64 v[244:245], 0
v_mov_b64 v[246:247], 0
v_mov_b32 v16, 0x03020302
v_mov_b32 v18, 0x0c0c0c0c
v_cmp_gt_u32 vcc, 32, v1
s_nop 1
v_cndmask_b32 v16, v18, v16, vcc
s_lshl_b32 s67, s63, 2
s_and_b32 s68, s65, 2
s_add_u32 s67, s67, s68
s_mul_i32 s67, s67, 144
s_lshl_b32 s68, s64, 3
s_add_u32 s68, s68, s67
s_add_u32 s68, s68, 32
s_lshl_b32 s68, s68, 10
s_add_u32 s67, s68, 4096
v_add_u32 v19, 147456, v8
s_lshr_b32 s70, s65, 1
s_lshl_b32 s70, s70, 6
s_add_u32 s70, s70, 16
v_and_b32 v20, 31, v1
v_add_u32 v20, s70, v20
v_mul_u32_u24 v20, 208, v20
v_lshrrev_b32 v12, 5, v1
v_lshl_add_u32 v20, v12, 4, v20
v_add_u32 v20, 114688, v20
s_barrier
ds_read_b32 v10, v11 offset:8
ds_read_b32 v38, v9 offset:384
ds_read_b32 v40, v9 offset:512
ds_read_b32 v42, v9 offset:640
ds_read_b32 v32, v9 offset:0
ds_read_b32 v34, v9 offset:128
ds_read_b32 v36, v9 offset:256
s_mov_b32 s57, 0
s_waitcnt vmcnt(0) lgkmcnt(0)
M0_STC:
v_cmp_ne_u32 vcc, v27, v10
v_cmp_ne_u32 s[54:55], v29, v10
v_readfirstlane_b32 s75, v10
s_or_b64 vcc, vcc, s[54:55]
s_cbranch_scc1 M0_STR
M0_STOK:
v_perm_b32 v240, v26, v26, v16
v_perm_b32 v244, v28, v28, v16
v_lshlrev_b32 v27, 16, v26
v_rcp_f32 v27, v27
v_lshlrev_b32 v29, 16, v28
v_rcp_f32 v29, v29
v_mfma_f32_32x32x16_bf16 v[64:79], v[32:35], v[240:243], v[64:79]
v_mfma_f32_32x32x16_bf16 v[80:95], v[32:35], v[244:247], v[80:95]
s_nop 10
v_pk_mul_f32 v[64:65], v[26:27], v[64:65] op_sel:[1,0] op_sel_hi:[1,1]
v_pk_mul_f32 v[66:67], v[26:27], v[66:67] op_sel:[1,0] op_sel_hi:[1,1]
v_pk_mul_f32 v[68:69], v[26:27], v[68:69] op_sel:[1,0] op_sel_hi:[1,1]
v_pk_mul_f32 v[70:71], v[26:27], v[70:71] op_sel:[1,0] op_sel_hi:[1,1]
v_pk_mul_f32 v[72:73], v[26:27], v[72:73] op_sel:[1,0] op_sel_hi:[1,1]
v_pk_mul_f32 v[74:75], v[26:27], v[74:75] op_sel:[1,0] op_sel_hi:[1,1]
v_pk_mul_f32 v[76:77], v[26:27], v[76:77] op_sel:[1,0] op_sel_hi:[1,1]
v_pk_mul_f32 v[78:79], v[26:27], v[78:79] op_sel:[1,0] op_sel_hi:[1,1]
v_mfma_f32_32x32x16_bf16 v[96:111], v[34:37], v[240:243], v[96:111]
v_cvt_pk_bf16_f32 v64, v64, v65
v_cvt_pk_bf16_f32 v65, v66, v67
v_cvt_pk_bf16_f32 v66, v68, v69
v_cvt_pk_bf16_f32 v67, v70, v71
v_cvt_pk_bf16_f32 v68, v72, v73
v_cvt_pk_bf16_f32 v69, v74, v75
v_cvt_pk_bf16_f32 v70, v76, v77
v_cvt_pk_bf16_f32 v71, v78, v79
ds_write_b128 v20, v[64:67] offset:0
ds_write_b128 v20, v[68:71] offset:32
v_pk_mul_f32 v[80:81], v[28:29], v[80:81] op_sel:[1,0] op_sel_hi:[1,1]
v_pk_mul_f32 v[82:83], v[28:29], v[82:83] op_sel:[1,0] op_sel_hi:[1,1]
v_pk_mul_f32 v[84:85], v[28:29], v[84:85] op_sel:[1,0] op_sel_hi:[1,1]
v_pk_mul_f32 v[86:87], v[28:29], v[86:87] op_sel:[1,0] op_sel_hi:[1,1]
v_pk_mul_f32 v[88:89], v[28:29], v[88:89] op_sel:[1,0] op_sel_hi:[1,1]
v_pk_mul_f32 v[90:91], v[28:29], v[90:91] op_sel:[1,0] op_sel_hi:[1,1]
v_pk_mul_f32 v[92:93], v[28:29], v[92:93] op_sel:[1,0] op_sel_hi:[1,1]
v_pk_mul_f32 v[94:95], v[28:29], v[94:95] op_sel:[1,0] op_sel_hi:[1,1]
v_mfma_f32_32x32x16_bf16 v[112:127], v[34:37], v[244:247], v[112:127]
v_cvt_pk_bf16_f32 v80, v80, v81
v_cvt_pk_bf16_f32 v81, v82, v83
v_cvt_pk_bf16_f32 v82, v84, v85
v_cvt_pk_bf16_f32 v83, v86, v87
v_cvt_pk_bf16_f32 v84, v88, v89
v_cvt_pk_bf16_f32 v85, v90, v91
v_cvt_pk_bf16_f32 v86, v92, v93
v_cvt_pk_bf16_f32 v87, v94, v95
ds_write_b128 v20, v[80:83] offset:6656
ds_write_b128 v20, v[84:87] offset:6688
v_pk_mul_f32 v[96:97], v[26:27], v[96:97] op_sel:[1,0] op_sel_hi:[1,1]
v_pk_mul_f32 v[98:99], v[26:27], v[98:99] op_sel:[1,0] op_sel_hi:[1,1]
v_pk_mul_f32 v[100:101], v[26:27], v[100:101] op_sel:[1,0] op_sel_hi:[1,1]
v_pk_mul_f32 v[102:103], v[26:27], v[102:103] op_sel:[1,0] op_sel_hi:[1,1]
v_pk_mul_f32 v[104:105], v[26:27], v[104:105] op_sel:[1,0] op_sel_hi:[1,1]
v_pk_mul_f32 v[106:107], v[26:27], v[106:107] op_sel:[1,0] op_sel_hi:[1,1]
v_pk_mul_f32 v[108:109], v[26:27], v[108:109] op_sel:[1,0] op_sel_hi:[1,1]
v_pk_mul_f32 v[110:111], v[26:27], v[110:111] op_sel:[1,0] op_sel_hi:[1,1]
v_mfma_f32_32x32x16_bf16 v[128:143], v[36:39], v[240:243], v[128:143]
v_cvt_pk_bf16_f32 v96, v96, v97
v_cvt_pk_bf16_f32 v97, v98, v99
v_cvt_pk_bf16_f32 v98, v100, v101
v_cvt_pk_bf16_f32 v99, v102, v103
v_cvt_pk_bf16_f32 v100, v104, v105
v_cvt_pk_bf16_f32 v101, v106, v107
v_cvt_pk_bf16_f32 v102, v108, v109
v_cvt_pk_bf16_f32 v103, v110, v111
ds_write_b128 v20, v[96:99] offset:64
ds_write_b128 v20, v[100:103] offset:96
v_pk_mul_f32 v[112:113], v[28:29], v[112:113] op_sel:[1,0] op_sel_hi:[1,1]
v_pk_mul_f32 v[114:115], v[28:29], v[114:115] op_sel:[1,0] op_sel_hi:[1,1]
v_pk_mul_f32 v[116:117], v[28:29], v[116:117] op_sel:[1,0] op_sel_hi:[1,1]
v_pk_mul_f32 v[118:119], v[28:29], v[118:119] op_sel:[1,0] op_sel_hi:[1,1]
v_pk_mul_f32 v[120:121], v[28:29], v[120:121] op_sel:[1,0] op_sel_hi:[1,1]
v_pk_mul_f32 v[122:123], v[28:29], v[122:123] op_sel:[1,0] op_sel_hi:[1,1]
v_pk_mul_f32 v[124:125], v[28:29], v[124:125] op_sel:[1,0] op_sel_hi:[1,1]
v_pk_mul_f32 v[126:127], v[28:29], v[126:127] op_sel:[1,0] op_sel_hi:[1,1]
v_mfma_f32_32x32x16_bf16 v[144:159], v[36:39], v[244:247], v[144:159]
v_cvt_pk_bf16_f32 v112, v112, v113
v_cvt_pk_bf16_f32 v113, v114, v115
v_cvt_pk_bf16_f32 v114, v116, v117
v_cvt_pk_bf16_f32 v115, v118, v119
v_cvt_pk_bf16_f32 v116, v120, v121
v_cvt_pk_bf16_f32 v117, v122, v123
v_cvt_pk_bf16_f32 v118, v124, v125
v_cvt_pk_bf16_f32 v119, v126, v127
ds_write_b128 v20, v[112:115] offset:6720
ds_write_b128 v20, v[116:119] offset:6752
v_pk_mul_f32 v[128:129], v[26:27], v[128:129] op_sel:[1,0] op_sel_hi:[1,1]
v_pk_mul_f32 v[130:131], v[26:27], v[130:131] op_sel:[1,0] op_sel_hi:[1,1]
v_pk_mul_f32 v[132:133], v[26:27], v[132:133] op_sel:[1,0] op_sel_hi:[1,1]
v_pk_mul_f32 v[134:135], v[26:27], v[134:135] op_sel:[1,0] op_sel_hi:[1,1]
v_pk_mul_f32 v[136:137], v[26:27], v[136:137] op_sel:[1,0] op_sel_hi:[1,1]
v_pk_mul_f32 v[138:139], v[26:27], v[138:139] op_sel:[1,0] op_sel_hi:[1,1]
v_pk_mul_f32 v[140:141], v[26:27], v[140:141] op_sel:[1,0] op_sel_hi:[1,1]
v_pk_mul_f32 v[142:143], v[26:27], v[142:143] op_sel:[1,0] op_sel_hi:[1,1]
v_cvt_pk_bf16_f32 v128, v128, v129
v_cvt_pk_bf16_f32 v129, v130, v131
v_cvt_pk_bf16_f32 v130, v132, v133
v_cvt_pk_bf16_f32 v131, v134, v135
v_cvt_pk_bf16_f32 v132, v136, v137
v_cvt_pk_bf16_f32 v133, v138, v139
v_cvt_pk_bf16_f32 v134, v140, v141
v_cvt_pk_bf16_f32 v135, v142, v143
ds_write_b128 v20, v[128:131] offset:128
ds_write_b128 v20, v[132:135] offset:160
v_pk_mul_f32 v[144:145], v[28:29], v[144:145] op_sel:[1,0] op_sel_hi:[1,1]
v_pk_mul_f32 v[146:147], v[28:29], v[146:147] op_sel:[1,0] op_sel_hi:[1,1]
v_pk_mul_f32 v[148:149], v[28:29], v[148:149] op_sel:[1,0] op_sel_hi:[1,1]
v_pk_mul_f32 v[150:151], v[28:29], v[150:151] op_sel:[1,0] op_sel_hi:[1,1]
v_pk_mul_f32 v[152:153], v[28:29], v[152:153] op_sel:[1,0] op_sel_hi:[1,1]
v_pk_mul_f32 v[154:155], v[28:29], v[154:155] op_sel:[1,0] op_sel_hi:[1,1]
v_pk_mul_f32 v[156:157], v[28:29], v[156:157] op_sel:[1,0] op_sel_hi:[1,1]
v_pk_mul_f32 v[158:159], v[28:29], v[158:159] op_sel:[1,0] op_sel_hi:[1,1]
v_cvt_pk_bf16_f32 v144, v144, v145
v_cvt_pk_bf16_f32 v145, v146, v147
v_cvt_pk_bf16_f32 v146, v148, v149
v_cvt_pk_bf16_f32 v147, v150, v151
v_cvt_pk_bf16_f32 v148, v152, v153
v_cvt_pk_bf16_f32 v149, v154, v155
v_cvt_pk_bf16_f32 v150, v156, v157
v_cvt_pk_bf16_f32 v151, v158, v159
ds_write_b128 v20, v[144:147] offset:6784
ds_write_b128 v20, v[148:151] offset:6816
v_mov_b32 v21, 147392
v_mov_b32 v22, 1
s_mov_b64 exec, 1
s_waitcnt lgkmcnt(0)
ds_add_u32 v21, v22
s_mov_b64 exec, -1
s_cmp_lt_u32 s64, 14
s_cbranch_scc0 M0_SKIPG
v_mfma_f32_32x32x16_bf16 v[160:175], v[38:41], v[240:243], v[160:175]
v_mfma_f32_32x32x16_bf16 v[176:191], v[38:41], v[244:247], v[176:191]
s_nop 10
v_max_f32 v160, 0, v160
v_max_f32 v161, 0, v161
v_max_f32 v162, 0, v162
v_max_f32 v163, 0, v163
v_max_f32 v164, 0, v164
v_max_f32 v165, 0, v165
v_max_f32 v166, 0, v166
v_max_f32 v167, 0, v167
v_mfma_f32_32x32x16_bf16 v[192:207], v[40:43], v[240:243], v[192:207]
v_pk_mul_f32 v[160:161], v[160:161], v[168:169]
v_pk_mul_f32 v[162:163], v[162:163], v[170:171]
v_pk_mul_f32 v[164:165], v[164:165], v[172:173]
v_pk_mul_f32 v[166:167], v[166:167], v[174:175]
v_cvt_pk_bf16_f32 v168, v160, v161
v_cvt_pk_bf16_f32 v169, v162, v163
v_cvt_pk_bf16_f32 v170, v164, v165
v_cvt_pk_bf16_f32 v171, v166, v167
buffer_store_dwordx4 v[168:171], v8, s[36:39], s68 offen offset:0 sc0 sc1
v_max_f32 v176, 0, v176
v_max_f32 v177, 0, v177
v_max_f32 v178, 0, v178
v_max_f32 v179, 0, v179
v_max_f32 v180, 0, v180
v_max_f32 v181, 0, v181
v_max_f32 v182, 0, v182
v_max_f32 v183, 0, v183
v_mfma_f32_32x32x16_bf16 v[208:223], v[40:43], v[244:247], v[208:223]
v_pk_mul_f32 v[176:177], v[176:177], v[184:185]
v_pk_mul_f32 v[178:179], v[178:179], v[186:187]
v_pk_mul_f32 v[180:181], v[180:181], v[188:189]
v_pk_mul_f32 v[182:183], v[182:183], v[190:191]
v_cvt_pk_bf16_f32 v184, v176, v177
v_cvt_pk_bf16_f32 v185, v178, v179
v_cvt_pk_bf16_f32 v186, v180, v181
v_cvt_pk_bf16_f32 v187, v182, v183
buffer_store_dwordx4 v[184:187], v19, s[36:39], s68 offen offset:0 sc0 sc1
v_max_f32 v192, 0, v192
v_max_f32 v193, 0, v193
v_max_f32 v194, 0, v194
v_max_f32 v195, 0, v195
v_max_f32 v196, 0, v196
v_max_f32 v197, 0, v197
v_max_f32 v198, 0, v198
v_max_f32 v199, 0, v199
v_mfma_f32_32x32x16_bf16 v[224:239], v[42:45], v[240:243], v[224:239]
v_pk_mul_f32 v[192:193], v[192:193], v[200:201]
v_pk_mul_f32 v[194:195], v[194:195], v[202:203]
v_pk_mul_f32 v[196:197], v[196:197], v[204:205]
v_pk_mul_f32 v[198:199], v[198:199], v[206:207]
v_cvt_pk_bf16_f32 v200, v192, v193
v_cvt_pk_bf16_f32 v201, v194, v195
v_cvt_pk_bf16_f32 v202, v196, v197
v_cvt_pk_bf16_f32 v203, v198, v199
buffer_store_dwordx4 v[200:203], v8, s[36:39], s68 offen offset:1024 sc0 sc1
v_max_f32 v208, 0, v208
v_max_f32 v209, 0, v209
v_max_f32 v210, 0, v210
v_max_f32 v211, 0, v211
v_max_f32 v212, 0, v212
v_max_f32 v213, 0, v213
v_max_f32 v214, 0, v214
v_max_f32 v215, 0, v215
v_pk_mul_f32 v[208:209], v[208:209], v[216:217]
v_pk_mul_f32 v[210:211], v[210:211], v[218:219]
v_pk_mul_f32 v[212:213], v[212:213], v[220:221]
v_pk_mul_f32 v[214:215], v[214:215], v[222:223]
v_cvt_pk_bf16_f32 v216, v208, v209
v_cvt_pk_bf16_f32 v217, v210, v211
v_cvt_pk_bf16_f32 v218, v212, v213
v_cvt_pk_bf16_f32 v219, v214, v215
buffer_store_dwordx4 v[216:219], v19, s[36:39], s68 offen offset:1024 sc0 sc1
v_max_f32 v224, 0, v224
v_max_f32 v225, 0, v225
v_max_f32 v226, 0, v226
v_max_f32 v227, 0, v227
v_max_f32 v228, 0, v228
v_max_f32 v229, 0, v229
v_max_f32 v230, 0, v230
v_max_f32 v231, 0, v231
v_pk_mul_f32 v[224:225], v[224:225], v[232:233]
v_pk_mul_f32 v[226:227], v[226:227], v[234:235]
v_pk_mul_f32 v[228:229], v[228:229], v[236:237]
v_pk_mul_f32 v[230:231], v[230:231], v[238:239]
v_cvt_pk_bf16_f32 v232, v224, v225
v_cvt_pk_bf16_f32 v233, v226, v227
v_cvt_pk_bf16_f32 v234, v228, v229
v_cvt_pk_bf16_f32 v235, v230, v231
buffer_store_dwordx4 v[232:235], v8, s[36:39], s68 offen offset:2048 sc0 sc1
M0_SKIPG:
v_lshrrev_b32 v3, 3, v1
v_and_b32 v4, 7, v1
v_bfe_u32 v5, v1, 4, 1
v_lshlrev_b32 v5, 2, v5
v_xor_b32 v4, v4, v5
v_lshlrev_b32 v3, 10, v3
v_lshl_add_u32 v2, v4, 4, v3
s_setprio 0
s_branch MT
M0_SL0:
s_mov_b32 s67, 0
M0_SL0L:
s_sleep 0
ds_read_b32 v10, v11
s_add_u32 s67, s67, 1
s_waitcnt lgkmcnt(0)
v_cmp_gt_u32 vcc, s57, v10
s_cmp_gt_u32 s67, 200000
s_cbranch_scc1 M0_RT0
s_cbranch_vccnz M0_SL0L
s_branch M0_RT0
M0_SL1:
s_mov_b32 s67, 0
M0_SL1L:
s_sleep 0
ds_read_b32 v10, v11
s_add_u32 s67, s67, 1
s_waitcnt lgkmcnt(0)
v_cmp_gt_u32 vcc, s57, v10
s_cmp_gt_u32 s67, 200000
s_cbranch_scc1 M0_RT1
s_cbranch_vccnz M0_SL1L
s_branch M0_RT1
M0_SL2:
s_mov_b32 s67, 0
M0_SL2L:
s_sleep 0
ds_read_b32 v10, v11
s_add_u32 s67, s67, 1
s_waitcnt lgkmcnt(0)
v_cmp_gt_u32 vcc, s57, v10
s_cmp_gt_u32 s67, 200000
s_cbranch_scc1 M0_RT2
s_cbranch_vccnz M0_SL2L
s_branch M0_RT2
M0_SL3:
s_mov_b32 s67, 0
M0_SL3L:
s_sleep 0
ds_read_b32 v10, v11
s_add_u32 s67, s67, 1
s_waitcnt lgkmcnt(0)
v_cmp_gt_u32 vcc, s57, v10
s_cmp_gt_u32 s67, 200000
s_cbranch_scc1 M0_RT3
s_cbranch_vccnz M0_SL3L
s_branch M0_RT3
M0_PF0:
buffer_load_dword v15, v14, s[28:31], s49 offen
s_add_u32 s49, s49, s50
s_cmp_ge_u32 s49, s59
s_cselect_b32 s67, s71, 0
s_sub_u32 s49, s49, s67
s_add_u32 s48, s48, s51
s_mov_b32 s51, 0x1000
s_branch M0_PR0
M0_PF1:
buffer_load_dword v15, v14, s[28:31], s49 offen
s_add_u32 s49, s49, s50
s_cmp_ge_u32 s49, s59
s_cselect_b32 s67, s71, 0
s_sub_u32 s49, s49, s67
s_add_u32 s48, s48, s51
s_mov_b32 s51, 0x1000
s_branch M0_PR1
M0_PF2:
buffer_load_dword v15, v14, s[28:31], s49 offen
s_add_u32 s49, s49, s50
s_cmp_ge_u32 s49, s59
s_cselect_b32 s67, s71, 0
s_sub_u32 s49, s49, s67
s_add_u32 s48, s48, s51
s_mov_b32 s51, 0x1000
s_branch M0_PR2
M0_PF3:
buffer_load_dword v15, v14, s[28:31], s49 offen
s_add_u32 s49, s49, s50
s_cmp_ge_u32 s49, s59
s_cselect_b32 s67, s71, 0
s_sub_u32 s49, s49, s67
s_add_u32 s48, s48, s51
s_mov_b32 s51, 0x1000
s_branch M0_PR3
M0_STR:
s_add_u32 s57, s57, 1
s_cmp_gt_u32 s57, 100000
s_cbranch_scc1 M0_STOK
s_sleep 8
buffer_load_dwordx2 v[26:27], v25, s[36:39], s56 offen offset:0 sc0 sc1
buffer_load_dwordx2 v[28:29], v25, s[36:39], s56 offen offset:256 sc0 sc1
s_waitcnt vmcnt(0)
s_branch M0_STC
MP1:
s_nop 3
v_lshrrev_b32 v9, 5, v1
v_bfe_u32 v10, v1, 4, 1
v_bfe_u32 v11, v1, 2, 2
v_and_b32 v12, 3, v1
v_lshl_add_u32 v13, v9, 3, v11
v_lshlrev_b32 v14, 8, v13
v_mov_b32 v15, 8320
v_mad_u32_u24 v14, v10, v15, v14
v_lshl_add_u32 v14, v12, 3, v14
v_add_u32 v14, 18432, v14
v_xor_b32 v15, 0, v11
v_lshl_add_u32 v40, v15, 5, v14
v_xor_b32 v15, 1, v11
v_lshl_add_u32 v41, v15, 5, v14
v_xor_b32 v15, 2, v11
v_lshl_add_u32 v42, v15, 5, v14
v_xor_b32 v15, 3, v11
v_lshl_add_u32 v43, v15, 5, v14
v_and_b32 v15, 31, v1
v_bfe_u32 v16, v1, 1, 3
v_xor_b32 v16, v16, v9
s_lshr_b32 s70, s65, 1
s_lshl_b32 s70, s70, 6
s_add_u32 s70, s70, 16
v_add_u32 v15, s70, v15
v_lshlrev_b32 v15, 7, v15
v_lshl_add_u32 v24, v16, 4, v15
v_mov_b32 v2, v40
v_add_u32 v6, 63744, v40
v_mov_b32 v3, v41
v_add_u32 v7, 63744, v41
v_mov_b32 v4, v42
v_add_u32 v8, 63744, v42
v_mov_b32 v5, v43
v_add_u32 v9, 63744, v43
s_mov_b32 s53, 63744
s_mov_b32 s54, 127488
s_mov_b32 s55, 0
s_mov_b32 s58, 0
s_mov_b32 s57, 2
v_add_u32 v20, s53, v24
v_xor_b32 v21, 32, v20
v_xor_b32 v22, 64, v20
v_xor_b32 v23, 96, v20
v_mov_b32 v11, 147408
s_lshl_b32 s67, s60, 2
s_add_u32 s67, s67, 147424
v_mov_b32 v13, s67
v_mov_b32 v12, 0
v_mov_b64 v[64:65], 0
v_mov_b64 v[66:67], 0
v_mov_b64 v[68:69], 0
v_mov_b64 v[70:71], 0
v_mov_b64 v[72:73], 0
v_mov_b64 v[74:75], 0
v_mov_b64 v[76:77], 0
v_mov_b64 v[78:79], 0
v_mov_b64 v[80:81], 0
v_mov_b64 v[82:83], 0
v_mov_b64 v[84:85], 0
v_mov_b64 v[86:87], 0
v_mov_b64 v[88:89], 0
v_mov_b64 v[90:91], 0
v_mov_b64 v[92:93], 0
v_mov_b64 v[94:95], 0
v_mov_b64 v[96:97], 0
v_mov_b64 v[98:99], 0
v_mov_b64 v[100:101], 0
v_mov_b64 v[102:103], 0
v_mov_b64 v[104:105], 0
v_mov_b64 v[106:107], 0
v_mov_b64 v[108:109], 0
v_mov_b64 v[110:111], 0
v_mov_b64 v[112:113], 0
v_mov_b64 v[114:115], 0
v_mov_b64 v[116:117], 0
v_mov_b64 v[118:119], 0
v_mov_b64 v[120:121], 0
v_mov_b64 v[122:123], 0
v_mov_b64 v[124:125], 0
v_mov_b64 v[126:127], 0
v_mov_b64 v[128:129], 0
v_mov_b64 v[130:131], 0
v_mov_b64 v[132:133], 0
v_mov_b64 v[134:135], 0
v_mov_b64 v[136:137], 0
v_mov_b64 v[138:139], 0
v_mov_b64 v[140:141], 0
v_mov_b64 v[142:143], 0
v_mov_b64 v[144:145], 0
v_mov_b64 v[146:147], 0
v_mov_b64 v[148:149], 0
v_mov_b64 v[150:151], 0
v_mov_b64 v[152:153], 0
v_mov_b64 v[154:155], 0
v_mov_b64 v[156:157], 0
v_mov_b64 v[158:159], 0
v_mov_b64 v[160:161], 0
v_mov_b64 v[162:163], 0
v_mov_b64 v[164:165], 0
v_mov_b64 v[166:167], 0
v_mov_b64 v[168:169], 0
v_mov_b64 v[170:171], 0
v_mov_b64 v[172:173], 0
v_mov_b64 v[174:175], 0
v_mov_b64 v[176:177], 0
v_mov_b64 v[178:179], 0
v_mov_b64 v[180:181], 0
v_mov_b64 v[182:183], 0
v_mov_b64 v[184:185], 0
v_mov_b64 v[186:187], 0
v_mov_b64 v[188:189], 0
v_mov_b64 v[190:191], 0
v_mov_b64 v[192:193], 0
v_mov_b64 v[194:195], 0
v_mov_b64 v[196:197], 0
v_mov_b64 v[198:199], 0
v_mov_b64 v[200:201], 0
v_mov_b64 v[202:203], 0
v_mov_b64 v[204:205], 0
v_mov_b64 v[206:207], 0
v_mov_b64 v[208:209], 0
v_mov_b64 v[210:211], 0
v_mov_b64 v[212:213], 0
v_mov_b64 v[214:215], 0
v_mov_b64 v[216:217], 0
v_mov_b64 v[218:219], 0
v_mov_b64 v[220:221], 0
v_mov_b64 v[222:223], 0
v_mov_b64 v[224:225], 0
v_mov_b64 v[226:227], 0
v_mov_b64 v[228:229], 0
v_mov_b64 v[230:231], 0
v_mov_b64 v[232:233], 0
v_mov_b64 v[234:235], 0
v_mov_b64 v[236:237], 0
v_mov_b64 v[238:239], 0
s_mov_b32 s36, s22
s_mov_b32 s37, s23
s_mov_b32 s38, 67108864
s_mov_b32 s39, 0x00020000
s_lshl_b32 s67, s63, 7
s_lshr_b32 s68, s65, 1
s_lshl_b32 s68, s68, 6
s_add_u32 s67, s67, s68
s_lshl_b32 s67, s67, 3
s_add_u32 s56, s67, 10485760
v_and_b32 v25, 31, v1
v_lshlrev_b32 v25, 3, v25
s_and_b32 s67, s63, 7
s_mov_b32 s31, 0x00020000
s_mov_b32 s51, 0x1000
s_cmp_eq_u32 s60, 7
s_cbranch_scc1 M1_PFX
s_mov_b32 s28, s6
s_mov_b32 s29, s7
s_mov_b32 s30, 1572864
v_min_u32 v15, 47, v1
v_mul_u32_u24 v14, 86, v15
v_lshrrev_b32 v14, 8, v14
v_mul_u32_u24 v16, 3, v14
v_sub_u32 v15, v15, v16
v_mul_u32_u24 v14, 3072, v14
v_lshl_add_u32 v14, v15, 10, v14
s_mov_b32 s59, 1572864
s_mov_b32 s71, 1572864
s_mul_i32 s49, s63, 98304
s_lshl_b32 s68, s64, 6
s_add_u32 s49, s49, s68
s_and_b32 s68, s64, 1
s_mul_i32 s68, s68, 49152
s_add_u32 s49, s49, s68
s_mov_b32 s50, 786432
s_add_u32 s48, s67, 0
s_branch M1_PFG
M1_PFX:
s_mov_b32 s28, s4
s_mov_b32 s29, s5
s_mov_b32 s30, 2097152
v_and_b32 v14, 31, v1
v_lshlrev_b32 v14, 10, v14
v_lshrrev_b32 v15, 5, v1
v_lshl_add_u32 v14, v15, 7, v14
s_lshl_b32 s49, s63, 2
s_and_b32 s68, s64, 3
s_add_u32 s49, s49, s68
s_lshl_b32 s49, s49, 15
s_add_u32 s59, s49, 1024
s_mov_b32 s71, 1024
s_lshl_b32 s68, s66, 8
s_add_u32 s49, s49, s68
s_add_u32 s49, s49, 256
s_mov_b32 s50, 256
s_mov_b32 s48, 0
s_mov_b32 s51, 4
s_mov_b32 s67, 4
M1_PFG:
s_sub_u32 s67, s67, 4
s_cbranch_scc1 M1_PFI
M1_PFW:
s_sub_u32 s67, s67, 1
s_cbranch_scc1 M1_PFI
s_sleep 8
s_branch M1_PFW
M1_PFI:
buffer_load_dword v15, v14, s[28:31], s49 offen
M1_PFSK:
s_add_u32 s49, s49, s50
s_cmp_ge_u32 s49, s59
s_cselect_b32 s67, s71, 0
s_sub_u32 s49, s49, s67
s_waitcnt vmcnt(1)
v_lshlrev_b32 v32, 16, v240
v_and_b32 v33, 0xffff0000, v240
v_lshlrev_b32 v34, 16, v241
v_and_b32 v35, 0xffff0000, v241
v_lshlrev_b32 v36, 16, v242
v_and_b32 v37, 0xffff0000, v242
v_lshlrev_b32 v38, 16, v243
v_and_b32 v39, 0xffff0000, v243
v_lshlrev_b32 v40, 16, v244
v_and_b32 v41, 0xffff0000, v244
v_lshlrev_b32 v42, 16, v245
v_and_b32 v43, 0xffff0000, v245
v_lshlrev_b32 v44, 16, v246
v_and_b32 v45, 0xffff0000, v246
v_lshlrev_b32 v46, 16, v247
v_and_b32 v47, 0xffff0000, v247
v_add_f32 v48, v32, v33
v_mul_f32 v49, v32, v32
v_add_f32 v50, v40, v41
v_mul_f32 v51, v40, v40
v_fmac_f32 v49, v33, v33
v_fmac_f32 v51, v41, v41
v_add_f32 v48, v48, v34
v_fmac_f32 v49, v34, v34
v_add_f32 v50, v50, v42
v_fmac_f32 v51, v42, v42
v_add_f32 v48, v48, v35
v_fmac_f32 v49, v35, v35
v_add_f32 v50, v50, v43
v_fmac_f32 v51, v43, v43
v_add_f32 v48, v48, v36
v_fmac_f32 v49, v36, v36
v_add_f32 v50, v50, v44
v_fmac_f32 v51, v44, v44
v_add_f32 v48, v48, v37
v_fmac_f32 v49, v37, v37
v_add_f32 v50, v50, v45
v_fmac_f32 v51, v45, v45
v_add_f32 v48, v48, v38
v_fmac_f32 v49, v38, v38
v_add_f32 v50, v50, v46
v_fmac_f32 v51, v46, v46
v_add_f32 v48, v48, v39
v_fmac_f32 v49, v39, v39
v_add_f32 v50, v50, v47
v_fmac_f32 v51, v47, v47
v_add_f32_dpp v48, v48, v48 row_ror:8 row_mask:0xf bank_mask:0xf
v_add_f32_dpp v49, v49, v49 row_ror:8 row_mask:0xf bank_mask:0xf
v_add_f32_dpp v50, v50, v50 row_ror:8 row_mask:0xf bank_mask:0xf
v_add_f32_dpp v51, v51, v51 row_ror:8 row_mask:0xf bank_mask:0xf
v_add_f32_dpp v48, v48, v48 row_ror:4 row_mask:0xf bank_mask:0xf
v_add_f32_dpp v49, v49, v49 row_ror:4 row_mask:0xf bank_mask:0xf
v_add_f32_dpp v50, v50, v50 row_ror:4 row_mask:0xf bank_mask:0xf
v_add_f32_dpp v51, v51, v51 row_ror:4 row_mask:0xf bank_mask:0xf
v_add_f32_dpp v48, v48, v48 row_ror:2 row_mask:0xf bank_mask:0xf
v_add_f32_dpp v49, v49, v49 row_ror:2 row_mask:0xf bank_mask:0xf
v_add_f32_dpp v50, v50, v50 row_ror:2 row_mask:0xf bank_mask:0xf
v_add_f32_dpp v51, v51, v51 row_ror:2 row_mask:0xf bank_mask:0xf
v_add_f32_dpp v48, v48, v48 row_ror:1 row_mask:0xf bank_mask:0xf
v_add_f32_dpp v49, v49, v49 row_ror:1 row_mask:0xf bank_mask:0xf
v_add_f32_dpp v50, v50, v50 row_ror:1 row_mask:0xf bank_mask:0xf
v_add_f32_dpp v51, v51, v51 row_ror:1 row_mask:0xf bank_mask:0xf
v_mov_b32 v52, v48
v_mov_b32 v53, v49
v_mov_b32 v54, v50
v_mov_b32 v55, v51
v_permlane16_swap_b32 v48, v52
v_permlane16_swap_b32 v49, v53
v_permlane16_swap_b32 v50, v54
v_permlane16_swap_b32 v51, v55
v_add_f32 v48, v48, v52
v_add_f32 v49, v49, v53
v_add_f32 v50, v50, v54
v_add_f32 v51, v51, v55
v_mov_b32 v52, v48
v_mov_b32 v53, v49
v_mov_b32 v54, v50
v_mov_b32 v55, v51
v_permlane32_swap_b32 v48, v52
v_permlane32_swap_b32 v49, v53
v_permlane32_swap_b32 v50, v54
v_permlane32_swap_b32 v51, v55
v_add_f32 v48, v48, v52
v_add_f32 v49, v49, v53
v_add_f32 v50, v50, v54
v_add_f32 v51, v51, v55
v_mul_f32 v52, 0x3b000000, v48
v_mul_f32 v49, 0x3b000000, v49
v_fma_f32 v49, -v52, v52, v49
v_max_f32 v49, 0, v49
v_cvt_pk_bf16_f32 v56, v52, v52
v_lshlrev_b32 v52, 16, v56
v_cvt_pk_bf16_f32 v56, v49, v49
v_lshlrev_b32 v49, 16, v56
v_add_f32 v49, 0x3727c5ac, v49
v_cvt_pk_bf16_f32 v56, v49, v49
v_lshlrev_b32 v49, 16, v56
v_sqrt_f32 v49, v49
s_nop 0
v_cvt_pk_bf16_f32 v56, v49, v49
v_lshlrev_b32 v49, 16, v56
v_mul_f32 v53, 0x3b000000, v50
v_mul_f32 v51, 0x3b000000, v51
v_fma_f32 v51, -v53, v53, v51
v_max_f32 v51, 0, v51
v_cvt_pk_bf16_f32 v57, v53, v53
v_lshlrev_b32 v53, 16, v57
v_cvt_pk_bf16_f32 v57, v51, v51
v_lshlrev_b32 v51, 16, v57
v_add_f32 v51, 0x3727c5ac, v51
v_cvt_pk_bf16_f32 v57, v51, v51
v_lshlrev_b32 v51, 16, v57
v_sqrt_f32 v51, v51
s_nop 0
v_cvt_pk_bf16_f32 v57, v51, v51
v_lshlrev_b32 v51, 16, v57
v_lshrrev_b32 v49, 16, v49
v_or_b32 v52, v52, v49
v_lshrrev_b32 v51, 16, v51
v_or_b32 v53, v53, v51
s_lshl_b32 s67, s65, 3
s_add_u32 s67, s67, 147344
v_mov_b32 v56, s67
s_mov_b64 exec, 1
ds_write_b64 v56, v[52:53]
s_mov_b64 exec, -1
s_setprio 3
M1_S0:
s_mov_b32 s67, 0
M1_S0L:
s_sleep 1
ds_read_b32 v10, v11
s_add_u32 s67, s67, 1
s_waitcnt lgkmcnt(0)
v_cmp_gt_u32 vcc, s57, v10
s_cmp_gt_u32 s67, 200000
s_cbranch_scc1 M1_GO
s_cbranch_vccnz M1_S0L
s_branch M1_GO
M1_GO:
s_mov_b32 s57, 3
ds_read_b64_tr_b16 v[32:33], v5 offset:0
ds_read_b64_tr_b16 v[34:35], v5 offset:1024
ds_read_b64_tr_b16 v[36:37], v2 offset:128
ds_read_b64_tr_b16 v[38:39], v2 offset:1152
ds_read_b128 v[240:243], v20 offset:0
ds_read_b64_tr_b16 v[40:41], v3 offset:128
ds_read_b64_tr_b16 v[42:43], v3 offset:1152
ds_read_b128 v[244:247], v20 offset:4096
ds_read_b64_tr_b16 v[44:45], v4 offset:128
ds_read_b64_tr_b16 v[46:47], v4 offset:1152
ds_read_b64_tr_b16 v[48:49], v5 offset:128
ds_read_b64_tr_b16 v[50:51], v5 offset:1152
ds_read_b64_tr_b16 v[52:53], v4 offset:0
ds_read_b64_tr_b16 v[54:55], v4 offset:1024
ds_read_b64_tr_b16 v[56:57], v5 offset:4096
ds_read_b64_tr_b16 v[58:59], v5 offset:5120
M1_LOOP:
s_waitcnt lgkmcnt(11)
v_mfma_f32_32x32x16_bf16 v[64:79], v[32:35], v[240:243], v[64:79]
ds_read_b128 v[248:251], v21 offset:0
ds_read_b64_tr_b16 v[60:61], v2 offset:4224
ds_read_b64_tr_b16 v[62:63], v2 offset:5248
s_waitcnt lgkmcnt(11)
v_mfma_f32_32x32x16_bf16 v[80:95], v[32:35], v[244:247], v[80:95]
ds_read_b128 v[252:255], v21 offset:4096
v_mfma_f32_32x32x16_bf16 v[96:111], v[36:39], v[240:243], v[96:111]
s_sub_u32 s48, s48, 1
s_cbranch_scc1 M1_PF0
M1_PR0:
ds_read_b64_tr_b16 v[32:33], v3 offset:4224
ds_read_b64_tr_b16 v[34:35], v3 offset:5248
v_mfma_f32_32x32x16_bf16 v[112:127], v[36:39], v[244:247], v[112:127]
v_mfma_f32_32x32x16_bf16 v[128:143], v[40:43], v[240:243], v[128:143]
ds_read_b32 v10, v11
ds_read_b64_tr_b16 v[36:37], v4 offset:4224
ds_read_b64_tr_b16 v[38:39], v4 offset:5248
v_mfma_f32_32x32x16_bf16 v[144:159], v[40:43], v[244:247], v[144:159]
s_waitcnt lgkmcnt(15)
v_mfma_f32_32x32x16_bf16 v[160:175], v[44:47], v[240:243], v[160:175]
ds_read_b64_tr_b16 v[40:41], v5 offset:4224
ds_read_b64_tr_b16 v[42:43], v5 offset:5248
v_mfma_f32_32x32x16_bf16 v[176:191], v[44:47], v[244:247], v[176:191]
s_waitcnt lgkmcnt(15)
v_mfma_f32_32x32x16_bf16 v[192:207], v[48:51], v[240:243], v[192:207]
s_waitcnt lgkmcnt(4)
v_cmp_gt_u32 vcc, s57, v10
v_add_u32 v12, 1, v12
ds_read_b64_tr_b16 v[44:45], v4 offset:4096
ds_read_b64_tr_b16 v[46:47], v4 offset:5120
v_mfma_f32_32x32x16_bf16 v[208:223], v[48:51], v[244:247], v[208:223]
s_mov_b64 exec, 1
ds_write_b32 v13, v12
s_mov_b64 exec, -1
s_cbranch_vccnz M1_SL0
M1_RT0:
ds_read_b64_tr_b16 v[48:49], v5 offset:22656
ds_read_b64_tr_b16 v[50:51], v5 offset:23680
v_mfma_f32_32x32x16_bf16 v[224:239], v[52:55], v[244:247], v[224:239]
s_add_u32 s57, s57, 1
s_min_u32 s57, s57, 17
v_mfma_f32_32x32x16_bf16 v[64:79], v[56:59], v[248:251], v[64:79]
ds_read_b64_tr_b16 v[52:53], v2 offset:22784
ds_read_b64_tr_b16 v[54:55], v2 offset:23808
v_mfma_f32_32x32x16_bf16 v[80:95], v[56:59], v[252:255], v[80:95]
v_mfma_f32_32x32x16_bf16 v[96:111], v[60:63], v[248:251], v[96:111]
ds_read_b128 v[240:243], v22 offset:0
ds_read_b64_tr_b16 v[56:57], v3 offset:22784
ds_read_b64_tr_b16 v[58:59], v3 offset:23808
v_mfma_f32_32x32x16_bf16 v[112:127], v[60:63], v[252:255], v[112:127]
ds_read_b128 v[244:247], v22 offset:4096
v_mfma_f32_32x32x16_bf16 v[128:143], v[32:35], v[248:251], v[128:143]
ds_read_b64_tr_b16 v[60:61], v4 offset:22784
ds_read_b64_tr_b16 v[62:63], v4 offset:23808
v_mfma_f32_32x32x16_bf16 v[144:159], v[32:35], v[252:255], v[144:159]
s_waitcnt lgkmcnt(15)
v_mfma_f32_32x32x16_bf16 v[160:175], v[36:39], v[248:251], v[160:175]
ds_read_b64_tr_b16 v[32:33], v5 offset:22784
ds_read_b64_tr_b16 v[34:35], v5 offset:23808
v_mfma_f32_32x32x16_bf16 v[176:191], v[36:39], v[252:255], v[176:191]
s_waitcnt lgkmcnt(15)
v_mfma_f32_32x32x16_bf16 v[192:207], v[40:43], v[248:251], v[192:207]
ds_read_b64_tr_b16 v[36:37], v4 offset:22656
ds_read_b64_tr_b16 v[38:39], v4 offset:23680
v_mfma_f32_32x32x16_bf16 v[208:223], v[40:43], v[252:255], v[208:223]
ds_read_b64_tr_b16 v[40:41], v5 offset:26752
ds_read_b64_tr_b16 v[42:43], v5 offset:27776
s_waitcnt lgkmcnt(15)
v_mfma_f32_32x32x16_bf16 v[224:239], v[44:47], v[252:255], v[224:239]
s_waitcnt lgkmcnt(11)
v_mfma_f32_32x32x16_bf16 v[64:79], v[48:51], v[240:243], v[64:79]
ds_read_b128 v[248:251], v23 offset:0
ds_read_b64_tr_b16 v[44:45], v2 offset:26880
ds_read_b64_tr_b16 v[46:47], v2 offset:27904
s_waitcnt lgkmcnt(11)
v_mfma_f32_32x32x16_bf16 v[80:95], v[48:51], v[244:247], v[80:95]
ds_read_b128 v[252:255], v23 offset:4096
v_mfma_f32_32x32x16_bf16 v[96:111], v[52:55], v[240:243], v[96:111]
s_sub_u32 s48, s48, 1
s_cbranch_scc1 M1_PF1
M1_PR1:
ds_read_b64_tr_b16 v[48:49], v3 offset:26880
ds_read_b64_tr_b16 v[50:51], v3 offset:27904
v_mfma_f32_32x32x16_bf16 v[112:127], v[52:55], v[244:247], v[112:127]
v_mfma_f32_32x32x16_bf16 v[128:143], v[56:59], v[240:243], v[128:143]
ds_read_b32 v10, v11
ds_read_b64_tr_b16 v[52:53], v4 offset:26880
ds_read_b64_tr_b16 v[54:55], v4 offset:27904
v_mfma_f32_32x32x16_bf16 v[144:159], v[56:59], v[244:247], v[144:159]
s_waitcnt lgkmcnt(15)
v_mfma_f32_32x32x16_bf16 v[160:175], v[60:63], v[240:243], v[160:175]
ds_read_b64_tr_b16 v[56:57], v5 offset:26880
ds_read_b64_tr_b16 v[58:59], v5 offset:27904
v_mfma_f32_32x32x16_bf16 v[176:191], v[60:63], v[244:247], v[176:191]
s_waitcnt lgkmcnt(15)
v_mfma_f32_32x32x16_bf16 v[192:207], v[32:35], v[240:243], v[192:207]
s_waitcnt lgkmcnt(4)
v_cmp_gt_u32 vcc, s57, v10
v_add_u32 v12, 1, v12
ds_read_b64_tr_b16 v[60:61], v4 offset:26752
ds_read_b64_tr_b16 v[62:63], v4 offset:27776
v_mfma_f32_32x32x16_bf16 v[208:223], v[32:35], v[244:247], v[208:223]
s_mov_b64 exec, 1
ds_write_b32 v13, v12
s_mov_b64 exec, -1
s_cbranch_vccnz M1_SL1
M1_RT1:
ds_read_b64_tr_b16 v[32:33], v9 offset:0
ds_read_b64_tr_b16 v[34:35], v9 offset:1024
v_mfma_f32_32x32x16_bf16 v[224:239], v[36:39], v[244:247], v[224:239]
s_add_u32 s57, s57, 1
s_min_u32 s57, s57, 17
v_mfma_f32_32x32x16_bf16 v[64:79], v[40:43], v[248:251], v[64:79]
s_mov_b32 s70, s53
s_mov_b32 s53, s54
s_mov_b32 s54, s55
s_mov_b32 s55, s70
ds_read_b64_tr_b16 v[36:37], v6 offset:128
ds_read_b64_tr_b16 v[38:39], v6 offset:1152
v_mfma_f32_32x32x16_bf16 v[80:95], v[40:43], v[252:255], v[80:95]
v_add_u32 v20, s53, v24
v_xor_b32 v21, 32, v20
v_xor_b32 v22, 64, v20
v_xor_b32 v23, 96, v20
v_mfma_f32_32x32x16_bf16 v[96:111], v[44:47], v[248:251], v[96:111]
ds_read_b128 v[240:243], v20 offset:0
ds_read_b64_tr_b16 v[40:41], v7 offset:128
ds_read_b64_tr_b16 v[42:43], v7 offset:1152
s_cmp_lg_u32 s58, 3
s_cbranch_scc1 M1_NOST
buffer_load_dwordx2 v[26:27], v25, s[36:39], s56 offen offset:0 sc0 sc1
buffer_load_dwordx2 v[28:29], v25, s[36:39], s56 offen offset:256 sc0 sc1
M1_NOST:
v_mfma_f32_32x32x16_bf16 v[112:127], v[44:47], v[252:255], v[112:127]
ds_read_b128 v[244:247], v20 offset:4096
v_mfma_f32_32x32x16_bf16 v[128:143], v[48:51], v[248:251], v[128:143]
ds_read_b64_tr_b16 v[44:45], v8 offset:128
ds_read_b64_tr_b16 v[46:47], v8 offset:1152
v_mfma_f32_32x32x16_bf16 v[144:159], v[48:51], v[252:255], v[144:159]
s_waitcnt lgkmcnt(15)
v_mfma_f32_32x32x16_bf16 v[160:175], v[52:55], v[248:251], v[160:175]
ds_read_b64_tr_b16 v[48:49], v9 offset:128
ds_read_b64_tr_b16 v[50:51], v9 offset:1152
v_mfma_f32_32x32x16_bf16 v[176:191], v[52:55], v[252:255], v[176:191]
s_waitcnt lgkmcnt(15)
v_mfma_f32_32x32x16_bf16 v[192:207], v[56:59], v[248:251], v[192:207]
ds_read_b64_tr_b16 v[52:53], v8 offset:0
ds_read_b64_tr_b16 v[54:55], v8 offset:1024
v_mfma_f32_32x32x16_bf16 v[208:223], v[56:59], v[252:255], v[208:223]
ds_read_b64_tr_b16 v[56:57], v9 offset:4096
ds_read_b64_tr_b16 v[58:59], v9 offset:5120
s_waitcnt lgkmcnt(15)
v_mfma_f32_32x32x16_bf16 v[224:239], v[60:63], v[252:255], v[224:239]
s_waitcnt lgkmcnt(11)
v_mfma_f32_32x32x16_bf16 v[64:79], v[32:35], v[240:243], v[64:79]
ds_read_b128 v[248:251], v21 offset:0
ds_read_b64_tr_b16 v[60:61], v6 offset:4224
ds_read_b64_tr_b16 v[62:63], v6 offset:5248
s_waitcnt lgkmcnt(11)
v_mfma_f32_32x32x16_bf16 v[80:95], v[32:35], v[244:247], v[80:95]
ds_read_b128 v[252:255], v21 offset:4096
v_mfma_f32_32x32x16_bf16 v[96:111], v[36:39], v[240:243], v[96:111]
s_sub_u32 s48, s48, 1
s_cbranch_scc1 M1_PF2
M1_PR2:
ds_read_b64_tr_b16 v[32:33], v7 offset:4224
ds_read_b64_tr_b16 v[34:35], v7 offset:5248
v_mfma_f32_32x32x16_bf16 v[112:127], v[36:39], v[244:247], v[112:127]
v_mfma_f32_32x32x16_bf16 v[128:143], v[40:43], v[240:243], v[128:143]
ds_read_b32 v10, v11
ds_read_b64_tr_b16 v[36:37], v8 offset:4224
ds_read_b64_tr_b16 v[38:39], v8 offset:5248
v_mfma_f32_32x32x16_bf16 v[144:159], v[40:43], v[244:247], v[144:159]
s_waitcnt lgkmcnt(15)
v_mfma_f32_32x32x16_bf16 v[160:175], v[44:47], v[240:243], v[160:175]
ds_read_b64_tr_b16 v[40:41], v9 offset:4224
ds_read_b64_tr_b16 v[42:43], v9 offset:5248
v_mfma_f32_32x32x16_bf16 v[176:191], v[44:47], v[244:247], v[176:191]
s_waitcnt lgkmcnt(15)
v_mfma_f32_32x32x16_bf16 v[192:207], v[48:51], v[240:243], v[192:207]
s_waitcnt lgkmcnt(4)
v_cmp_gt_u32 vcc, s57, v10
v_add_u32 v12, 1, v12
ds_read_b64_tr_b16 v[44:45], v8 offset:4096
ds_read_b64_tr_b16 v[46:47], v8 offset:5120
v_mfma_f32_32x32x16_bf16 v[208:223], v[48:51], v[244:247], v[208:223]
s_mov_b64 exec, 1
ds_write_b32 v13, v12
s_mov_b64 exec, -1
s_cbranch_vccnz M1_SL2
M1_RT2:
ds_read_b64_tr_b16 v[48:49], v9 offset:22656
ds_read_b64_tr_b16 v[50:51], v9 offset:23680
v_mfma_f32_32x32x16_bf16 v[224:239], v[52:55], v[244:247], v[224:239]
s_add_u32 s57, s57, 1
s_min_u32 s57, s57, 17
v_mfma_f32_32x32x16_bf16 v[64:79], v[56:59], v[248:251], v[64:79]
ds_read_b64_tr_b16 v[52:53], v6 offset:22784
ds_read_b64_tr_b16 v[54:55], v6 offset:23808
v_mfma_f32_32x32x16_bf16 v[80:95], v[56:59], v[252:255], v[80:95]
v_mfma_f32_32x32x16_bf16 v[96:111], v[60:63], v[248:251], v[96:111]
ds_read_b128 v[240:243], v22 offset:0
ds_read_b64_tr_b16 v[56:57], v7 offset:22784
ds_read_b64_tr_b16 v[58:59], v7 offset:23808
v_mfma_f32_32x32x16_bf16 v[112:127], v[60:63], v[252:255], v[112:127]
ds_read_b128 v[244:247], v22 offset:4096
v_mfma_f32_32x32x16_bf16 v[128:143], v[32:35], v[248:251], v[128:143]
ds_read_b64_tr_b16 v[60:61], v8 offset:22784
ds_read_b64_tr_b16 v[62:63], v8 offset:23808
v_mfma_f32_32x32x16_bf16 v[144:159], v[32:35], v[252:255], v[144:159]
s_waitcnt lgkmcnt(15)
v_mfma_f32_32x32x16_bf16 v[160:175], v[36:39], v[248:251], v[160:175]
ds_read_b64_tr_b16 v[32:33], v9 offset:22784
ds_read_b64_tr_b16 v[34:35], v9 offset:23808
v_mfma_f32_32x32x16_bf16 v[176:191], v[36:39], v[252:255], v[176:191]
s_waitcnt lgkmcnt(15)
v_mfma_f32_32x32x16_bf16 v[192:207], v[40:43], v[248:251], v[192:207]
ds_read_b64_tr_b16 v[36:37], v8 offset:22656
ds_read_b64_tr_b16 v[38:39], v8 offset:23680
v_mfma_f32_32x32x16_bf16 v[208:223], v[40:43], v[252:255], v[208:223]
ds_read_b64_tr_b16 v[40:41], v9 offset:26752
ds_read_b64_tr_b16 v[42:43], v9 offset:27776
s_waitcnt lgkmcnt(15)
v_mfma_f32_32x32x16_bf16 v[224:239], v[44:47], v[252:255], v[224:239]
s_waitcnt lgkmcnt(11)
v_mfma_f32_32x32x16_bf16 v[64:79], v[48:51], v[240:243], v[64:79]
ds_read_b128 v[248:251], v23 offset:0
ds_read_b64_tr_b16 v[44:45], v6 offset:26880
ds_read_b64_tr_b16 v[46:47], v6 offset:27904
s_waitcnt lgkmcnt(11)
v_mfma_f32_32x32x16_bf16 v[80:95], v[48:51], v[244:247], v[80:95]
ds_read_b128 v[252:255], v23 offset:4096
v_mfma_f32_32x32x16_bf16 v[96:111], v[52:55], v[240:243], v[96:111]
s_sub_u32 s48, s48, 1
s_cbranch_scc1 M1_PF3
M1_PR3:
ds_read_b64_tr_b16 v[48:49], v7 offset:26880
ds_read_b64_tr_b16 v[50:51], v7 offset:27904
v_mfma_f32_32x32x16_bf16 v[112:127], v[52:55], v[244:247], v[112:127]
v_mfma_f32_32x32x16_bf16 v[128:143], v[56:59], v[240:243], v[128:143]
ds_read_b32 v10, v11
ds_read_b64_tr_b16 v[52:53], v8 offset:26880
ds_read_b64_tr_b16 v[54:55], v8 offset:27904
v_mfma_f32_32x32x16_bf16 v[144:159], v[56:59], v[244:247], v[144:159]
s_waitcnt lgkmcnt(15)
v_mfma_f32_32x32x16_bf16 v[160:175], v[60:63], v[240:243], v[160:175]
ds_read_b64_tr_b16 v[56:57], v9 offset:26880
ds_read_b64_tr_b16 v[58:59], v9 offset:27904
v_mfma_f32_32x32x16_bf16 v[176:191], v[60:63], v[244:247], v[176:191]
s_waitcnt lgkmcnt(15)
v_mfma_f32_32x32x16_bf16 v[192:207], v[32:35], v[240:243], v[192:207]
s_waitcnt lgkmcnt(4)
v_cmp_gt_u32 vcc, s57, v10
v_add_u32 v12, 1, v12
ds_read_b64_tr_b16 v[60:61], v8 offset:26752
ds_read_b64_tr_b16 v[62:63], v8 offset:27776
v_mfma_f32_32x32x16_bf16 v[208:223], v[32:35], v[244:247], v[208:223]
s_mov_b64 exec, 1
ds_write_b32 v13, v12
s_mov_b64 exec, -1
s_cbranch_vccnz M1_SL3
M1_RT3:
ds_read_b64_tr_b16 v[32:33], v5 offset:0
ds_read_b64_tr_b16 v[34:35], v5 offset:1024
v_mfma_f32_32x32x16_bf16 v[224:239], v[36:39], v[244:247], v[224:239]
s_add_u32 s57, s57, 1
s_min_u32 s57, s57, 17
v_mfma_f32_32x32x16_bf16 v[64:79], v[40:43], v[248:251], v[64:79]
s_mov_b32 s70, s53
s_mov_b32 s53, s54
s_mov_b32 s54, s55
s_mov_b32 s55, s70
ds_read_b64_tr_b16 v[36:37], v2 offset:128
ds_read_b64_tr_b16 v[38:39], v2 offset:1152
v_mfma_f32_32x32x16_bf16 v[80:95], v[40:43], v[252:255], v[80:95]
v_add_u32 v20, s53, v24
v_xor_b32 v21, 32, v20
v_xor_b32 v22, 64, v20
v_xor_b32 v23, 96, v20
v_mfma_f32_32x32x16_bf16 v[96:111], v[44:47], v[248:251], v[96:111]
ds_read_b128 v[240:243], v20 offset:0
ds_read_b64_tr_b16 v[40:41], v3 offset:128
ds_read_b64_tr_b16 v[42:43], v3 offset:1152
v_mfma_f32_32x32x16_bf16 v[112:127], v[44:47], v[252:255], v[112:127]
ds_read_b128 v[244:247], v20 offset:4096
v_mfma_f32_32x32x16_bf16 v[128:143], v[48:51], v[248:251], v[128:143]
ds_read_b64_tr_b16 v[44:45], v4 offset:128
ds_read_b64_tr_b16 v[46:47], v4 offset:1152
v_mfma_f32_32x32x16_bf16 v[144:159], v[48:51], v[252:255], v[144:159]
s_waitcnt lgkmcnt(15)
v_mfma_f32_32x32x16_bf16 v[160:175], v[52:55], v[248:251], v[160:175]
ds_read_b64_tr_b16 v[48:49], v5 offset:128
ds_read_b64_tr_b16 v[50:51], v5 offset:1152
v_mfma_f32_32x32x16_bf16 v[176:191], v[52:55], v[252:255], v[176:191]
s_waitcnt lgkmcnt(15)
v_mfma_f32_32x32x16_bf16 v[192:207], v[56:59], v[248:251], v[192:207]
ds_read_b64_tr_b16 v[52:53], v4 offset:0
ds_read_b64_tr_b16 v[54:55], v4 offset:1024
v_mfma_f32_32x32x16_bf16 v[208:223], v[56:59], v[252:255], v[208:223]
ds_read_b64_tr_b16 v[56:57], v5 offset:4096
ds_read_b64_tr_b16 v[58:59], v5 offset:5120
s_waitcnt lgkmcnt(15)
v_mfma_f32_32x32x16_bf16 v[224:239], v[60:63], v[252:255], v[224:239]
s_add_u32 s58, s58, 1
s_cmp_lt_u32 s58, 4
s_cbranch_scc1 M1_LOOP
s_mov_b32 s24, s4
s_mov_b32 s25, s5
s_mov_b32 s26, 2097152
s_mov_b32 s27, 0x00020000
s_lshl_b32 s48, s61, 2
s_and_b32 s67, s62, 3
s_add_u32 s48, s48, s67
s_lshr_b32 s49, s62, 2
s_mul_i32 s52, s60, 18
s_sub_i32 s67, s60, 2
s_max_i32 s67, s67, 0
s_min_i32 s67, s67, 2
s_lshl_b32 s67, s67, 1
s_add_u32 s52, s52, s67
s_lshr_b32 s67, s60, 1
s_cmp_eq_u32 s67, 1
s_cselect_b32 s51, 20, 18
s_add_u32 s74, s52, 32
s_mov_b32 s59, 0x02020202
s_sub_u32 s67, s60, 6
s_lshl_b32 s67, s67, 4
s_mov_b32 s46, 1835008
s_cmp_ge_u32 s60, 6
s_cselect_b32 s52, s67, s52
s_cselect_b32 s51, 16, s51
s_cselect_b32 s74, s67, s74
s_cselect_b32 s59, 0x04040404, s59
s_cselect_b32 s44, s8, s16
s_cselect_b32 s45, s9, s17
s_cselect_b32 s46, 524288, s46
s_mov_b32 s47, 0x00020000
s_lshl_b32 s73, s52, 14
s_lshl_b32 s67, s49, 7
s_add_u32 s73, s73, s67
s_lshl_b32 s69, s60, 11
s_mul_i32 s67, s48, 288
s_add_u32 s74, s74, s67
s_lshl_b32 s74, s74, 10
s_add_u32 s73, s73, 131072
v_and_b32 v9, 31, v1
v_lshlrev_b32 v9, 2, v9
v_add_u32 v9, 145920, v9
v_lshlrev_b32 v8, 4, v1
s_waitcnt lgkmcnt(0)
v_mov_b64 v[32:33], 0
v_mov_b64 v[34:35], 0
v_mov_b64 v[36:37], 0
v_mov_b64 v[38:39], 0
v_mov_b64 v[40:41], 0
v_mov_b64 v[42:43], 0
v_mov_b64 v[44:45], 0
v_mov_b64 v[46:47], 0
v_mov_b64 v[240:241], 0
v_mov_b64 v[242:243], 0
v_mov_b64 v[244:245], 0
v_mov_b64 v[246:247], 0
v_mov_b32 v16, 0x03020302
v_mov_b32 v18, 0x0c0c0c0c
v_cmp_gt_u32 vcc, 32, v1
s_nop 1
v_cndmask_b32 v16, v18, v16, vcc
s_lshl_b32 s67, s63, 2
s_and_b32 s68, s65, 2
s_add_u32 s67, s67, s68
s_mul_i32 s67, s67, 144
s_lshl_b32 s68, s64, 3
s_add_u32 s68, s68, s67
s_add_u32 s68, s68, 32
s_lshl_b32 s68, s68, 10
s_add_u32 s67, s68, 4096
v_add_u32 v19, 147456, v8
s_lshr_b32 s70, s65, 1
s_lshl_b32 s70, s70, 6
s_add_u32 s70, s70, 16
v_and_b32 v20, 31, v1
v_add_u32 v20, s70, v20
v_mul_u32_u24 v20, 208, v20
v_lshrrev_b32 v12, 5, v1
v_lshl_add_u32 v20, v12, 4, v20
v_add_u32 v20, 114688, v20
s_barrier
ds_read_b32 v10, v11 offset:8
ds_read_b32 v32, v9 offset:768
ds_read_b32 v34, v9 offset:896
ds_read_b32 v36, v9 offset:1024
ds_read_b32 v38, v9 offset:1152
ds_read_b32 v40, v9 offset:1280
ds_read_b32 v42, v9 offset:640
s_mov_b32 s57, 0
s_waitcnt vmcnt(0) lgkmcnt(0)
M1_STC:
v_cmp_ne_u32 vcc, v27, v10
v_cmp_ne_u32 s[54:55], v29, v10
v_readfirstlane_b32 s75, v10
s_or_b64 vcc, vcc, s[54:55]
s_cbranch_scc1 M1_STR
M1_STOK:
v_perm_b32 v240, v26, v26, v16
v_perm_b32 v244, v28, v28, v16
s_cmp_lt_u32 s64, 14
s_cbranch_scc0 M1_SKIPG
v_mfma_f32_32x32x16_bf16 v[64:79], v[32:35], v[240:243], v[64:79]
v_mfma_f32_32x32x16_bf16 v[80:95], v[32:35], v[244:247], v[80:95]
s_nop 10
v_max_f32 v64, 0, v64
v_max_f32 v65, 0, v65
v_max_f32 v66, 0, v66
v_max_f32 v67, 0, v67
v_max_f32 v68, 0, v68
v_max_f32 v69, 0, v69
v_max_f32 v70, 0, v70
v_max_f32 v71, 0, v71
v_mfma_f32_32x32x16_bf16 v[96:111], v[34:37], v[240:243], v[96:111]
v_pk_mul_f32 v[64:65], v[64:65], v[72:73]
v_pk_mul_f32 v[66:67], v[66:67], v[74:75]
v_pk_mul_f32 v[68:69], v[68:69], v[76:77]
v_pk_mul_f32 v[70:71], v[70:71], v[78:79]
v_cvt_pk_bf16_f32 v72, v64, v65
v_cvt_pk_bf16_f32 v73, v66, v67
v_cvt_pk_bf16_f32 v74, v68, v69
v_cvt_pk_bf16_f32 v75, v70, v71
buffer_store_dwordx4 v[72:75], v8, s[36:39], s68 offen offset:3072 sc0 sc1
v_max_f32 v80, 0, v80
v_max_f32 v81, 0, v81
v_max_f32 v82, 0, v82
v_max_f32 v83, 0, v83
v_max_f32 v84, 0, v84
v_max_f32 v85, 0, v85
v_max_f32 v86, 0, v86
v_max_f32 v87, 0, v87
v_mfma_f32_32x32x16_bf16 v[112:127], v[34:37], v[244:247], v[112:127]
v_pk_mul_f32 v[80:81], v[80:81], v[88:89]
v_pk_mul_f32 v[82:83], v[82:83], v[90:91]
v_pk_mul_f32 v[84:85], v[84:85], v[92:93]
v_pk_mul_f32 v[86:87], v[86:87], v[94:95]
v_cvt_pk_bf16_f32 v88, v80, v81
v_cvt_pk_bf16_f32 v89, v82, v83
v_cvt_pk_bf16_f32 v90, v84, v85
v_cvt_pk_bf16_f32 v91, v86, v87
buffer_store_dwordx4 v[88:91], v19, s[36:39], s68 offen offset:3072 sc0 sc1
v_max_f32 v96, 0, v96
v_max_f32 v97, 0, v97
v_max_f32 v98, 0, v98
v_max_f32 v99, 0, v99
v_max_f32 v100, 0, v100
v_max_f32 v101, 0, v101
v_max_f32 v102, 0, v102
v_max_f32 v103, 0, v103
v_mfma_f32_32x32x16_bf16 v[128:143], v[36:39], v[240:243], v[128:143]
v_pk_mul_f32 v[96:97], v[96:97], v[104:105]
v_pk_mul_f32 v[98:99], v[98:99], v[106:107]
v_pk_mul_f32 v[100:101], v[100:101], v[108:109]
v_pk_mul_f32 v[102:103], v[102:103], v[110:111]
v_cvt_pk_bf16_f32 v104, v96, v97
v_cvt_pk_bf16_f32 v105, v98, v99
v_cvt_pk_bf16_f32 v106, v100, v101
v_cvt_pk_bf16_f32 v107, v102, v103
buffer_store_dwordx4 v[104:107], v8, s[36:39], s67 offen offset:0 sc0 sc1
v_max_f32 v112, 0, v112
v_max_f32 v113, 0, v113
v_max_f32 v114, 0, v114
v_max_f32 v115, 0, v115
v_max_f32 v116, 0, v116
v_max_f32 v117, 0, v117
v_max_f32 v118, 0, v118
v_max_f32 v119, 0, v119
v_mfma_f32_32x32x16_bf16 v[144:159], v[36:39], v[244:247], v[144:159]
v_pk_mul_f32 v[112:113], v[112:113], v[120:121]
v_pk_mul_f32 v[114:115], v[114:115], v[122:123]
v_pk_mul_f32 v[116:117], v[116:117], v[124:125]
v_pk_mul_f32 v[118:119], v[118:119], v[126:127]
v_cvt_pk_bf16_f32 v120, v112, v113
v_cvt_pk_bf16_f32 v121, v114, v115
v_cvt_pk_bf16_f32 v122, v116, v117
v_cvt_pk_bf16_f32 v123, v118, v119
buffer_store_dwordx4 v[120:123], v19, s[36:39], s67 offen offset:0 sc0 sc1
v_max_f32 v128, 0, v128
v_max_f32 v129, 0, v129
v_max_f32 v130, 0, v130
v_max_f32 v131, 0, v131
v_max_f32 v132, 0, v132
v_max_f32 v133, 0, v133
v_max_f32 v134, 0, v134
v_max_f32 v135, 0, v135
v_mfma_f32_32x32x16_bf16 v[160:175], v[38:41], v[240:243], v[160:175]
v_pk_mul_f32 v[128:129], v[128:129], v[136:137]
v_pk_mul_f32 v[130:131], v[130:131], v[138:139]
v_pk_mul_f32 v[132:133], v[132:133], v[140:141]
v_pk_mul_f32 v[134:135], v[134:135], v[142:143]
v_cvt_pk_bf16_f32 v136, v128, v129
v_cvt_pk_bf16_f32 v137, v130, v131
v_cvt_pk_bf16_f32 v138, v132, v133
v_cvt_pk_bf16_f32 v139, v134, v135
buffer_store_dwordx4 v[136:139], v8, s[36:39], s67 offen offset:1024 sc0 sc1
v_max_f32 v144, 0, v144
v_max_f32 v145, 0, v145
v_max_f32 v146, 0, v146
v_max_f32 v147, 0, v147
v_max_f32 v148, 0, v148
v_max_f32 v149, 0, v149
v_max_f32 v150, 0, v150
v_max_f32 v151, 0, v151
v_mfma_f32_32x32x16_bf16 v[176:191], v[38:41], v[244:247], v[176:191]
v_pk_mul_f32 v[144:145], v[144:145], v[152:153]
v_pk_mul_f32 v[146:147], v[146:147], v[154:155]
v_pk_mul_f32 v[148:149], v[148:149], v[156:157]
v_pk_mul_f32 v[150:151], v[150:151], v[158:159]
v_cvt_pk_bf16_f32 v152, v144, v145
v_cvt_pk_bf16_f32 v153, v146, v147
v_cvt_pk_bf16_f32 v154, v148, v149
v_cvt_pk_bf16_f32 v155, v150, v151
buffer_store_dwordx4 v[152:155], v19, s[36:39], s67 offen offset:1024 sc0 sc1
v_max_f32 v160, 0, v160
v_max_f32 v161, 0, v161
v_max_f32 v162, 0, v162
v_max_f32 v163, 0, v163
v_max_f32 v164, 0, v164
v_max_f32 v165, 0, v165
v_max_f32 v166, 0, v166
v_max_f32 v167, 0, v167
v_mfma_f32_32x32x16_bf16 v[192:207], v[40:43], v[240:243], v[192:207]
v_pk_mul_f32 v[160:161], v[160:161], v[168:169]
v_pk_mul_f32 v[162:163], v[162:163], v[170:171]
v_pk_mul_f32 v[164:165], v[164:165], v[172:173]
v_pk_mul_f32 v[166:167], v[166:167], v[174:175]
v_cvt_pk_bf16_f32 v168, v160, v161
v_cvt_pk_bf16_f32 v169, v162, v163
v_cvt_pk_bf16_f32 v170, v164, v165
v_cvt_pk_bf16_f32 v171, v166, v167
buffer_store_dwordx4 v[168:171], v8, s[36:39], s67 offen offset:2048 sc0 sc1
v_max_f32 v176, 0, v176
v_max_f32 v177, 0, v177
v_max_f32 v178, 0, v178
v_max_f32 v179, 0, v179
v_max_f32 v180, 0, v180
v_max_f32 v181, 0, v181
v_max_f32 v182, 0, v182
v_max_f32 v183, 0, v183
v_mfma_f32_32x32x16_bf16 v[208:223], v[40:43], v[244:247], v[208:223]
v_pk_mul_f32 v[176:177], v[176:177], v[184:185]
v_pk_mul_f32 v[178:179], v[178:179], v[186:187]
v_pk_mul_f32 v[180:181], v[180:181], v[188:189]
v_pk_mul_f32 v[182:183], v[182:183], v[190:191]
v_cvt_pk_bf16_f32 v184, v176, v177
v_cvt_pk_bf16_f32 v185, v178, v179
v_cvt_pk_bf16_f32 v186, v180, v181
v_cvt_pk_bf16_f32 v187, v182, v183
buffer_store_dwordx4 v[184:187], v19, s[36:39], s67 offen offset:2048 sc0 sc1
v_max_f32 v192, 0, v192
v_max_f32 v193, 0, v193
v_max_f32 v194, 0, v194
v_max_f32 v195, 0, v195
v_max_f32 v196, 0, v196
v_max_f32 v197, 0, v197
v_max_f32 v198, 0, v198
v_max_f32 v199, 0, v199
v_mfma_f32_32x32x16_bf16 v[224:239], v[42:45], v[244:247], v[224:239]
v_pk_mul_f32 v[192:193], v[192:193], v[200:201]
v_pk_mul_f32 v[194:195], v[194:195], v[202:203]
v_pk_mul_f32 v[196:197], v[196:197], v[204:205]
v_pk_mul_f32 v[198:199], v[198:199], v[206:207]
v_cvt_pk_bf16_f32 v200, v192, v193
v_cvt_pk_bf16_f32 v201, v194, v195
v_cvt_pk_bf16_f32 v202, v196, v197
v_cvt_pk_bf16_f32 v203, v198, v199
buffer_store_dwordx4 v[200:203], v8, s[36:39], s67 offen offset:3072 sc0 sc1
v_max_f32 v208, 0, v208
v_max_f32 v209, 0, v209
v_max_f32 v210, 0, v210
v_max_f32 v211, 0, v211
v_max_f32 v212, 0, v212
v_max_f32 v213, 0, v213
v_max_f32 v214, 0, v214
v_max_f32 v215, 0, v215
v_pk_mul_f32 v[208:209], v[208:209], v[216:217]
v_pk_mul_f32 v[210:211], v[210:211], v[218:219]
v_pk_mul_f32 v[212:213], v[212:213], v[220:221]
v_pk_mul_f32 v[214:215], v[214:215], v[222:223]
v_cvt_pk_bf16_f32 v216, v208, v209
v_cvt_pk_bf16_f32 v217, v210, v211
v_cvt_pk_bf16_f32 v218, v212, v213
v_cvt_pk_bf16_f32 v219, v214, v215
buffer_store_dwordx4 v[216:219], v19, s[36:39], s67 offen offset:3072 sc0 sc1
v_max_f32 v224, 0, v224
v_max_f32 v225, 0, v225
v_max_f32 v226, 0, v226
v_max_f32 v227, 0, v227
v_max_f32 v228, 0, v228
v_max_f32 v229, 0, v229
v_max_f32 v230, 0, v230
v_max_f32 v231, 0, v231
v_pk_mul_f32 v[224:225], v[224:225], v[232:233]
v_pk_mul_f32 v[226:227], v[226:227], v[234:235]
v_pk_mul_f32 v[228:229], v[228:229], v[236:237]
v_pk_mul_f32 v[230:231], v[230:231], v[238:239]
v_cvt_pk_bf16_f32 v232, v224, v225
v_cvt_pk_bf16_f32 v233, v226, v227
v_cvt_pk_bf16_f32 v234, v228, v229
v_cvt_pk_bf16_f32 v235, v230, v231
buffer_store_dwordx4 v[232:235], v19, s[36:39], s68 offen offset:2048 sc0 sc1
M1_SKIPG:
v_lshrrev_b32 v3, 3, v1
v_and_b32 v4, 7, v1
v_bfe_u32 v5, v1, 4, 1
v_lshlrev_b32 v5, 2, v5
v_xor_b32 v4, v4, v5
v_lshlrev_b32 v3, 10, v3
v_lshl_add_u32 v2, v4, 4, v3
s_setprio 0
s_branch MT
M1_SL0:
s_mov_b32 s67, 0
M1_SL0L:
s_sleep 0
ds_read_b32 v10, v11
s_add_u32 s67, s67, 1
s_waitcnt lgkmcnt(0)
v_cmp_gt_u32 vcc, s57, v10
s_cmp_gt_u32 s67, 200000
s_cbranch_scc1 M1_RT0
s_cbranch_vccnz M1_SL0L
s_branch M1_RT0
M1_SL1:
s_mov_b32 s67, 0
M1_SL1L:
s_sleep 0
ds_read_b32 v10, v11
s_add_u32 s67, s67, 1
s_waitcnt lgkmcnt(0)
v_cmp_gt_u32 vcc, s57, v10
s_cmp_gt_u32 s67, 200000
s_cbranch_scc1 M1_RT1
s_cbranch_vccnz M1_SL1L
s_branch M1_RT1
M1_SL2:
s_mov_b32 s67, 0
M1_SL2L:
s_sleep 0
ds_read_b32 v10, v11
s_add_u32 s67, s67, 1
s_waitcnt lgkmcnt(0)
v_cmp_gt_u32 vcc, s57, v10
s_cmp_gt_u32 s67, 200000
s_cbranch_scc1 M1_RT2
s_cbranch_vccnz M1_SL2L
s_branch M1_RT2
M1_SL3:
s_mov_b32 s67, 0
M1_SL3L:
s_sleep 0
ds_read_b32 v10, v11
s_add_u32 s67, s67, 1
s_waitcnt lgkmcnt(0)
v_cmp_gt_u32 vcc, s57, v10
s_cmp_gt_u32 s67, 200000
s_cbranch_scc1 M1_RT3
s_cbranch_vccnz M1_SL3L
s_branch M1_RT3
M1_PF0:
buffer_load_dword v15, v14, s[28:31], s49 offen
s_add_u32 s49, s49, s50
s_cmp_ge_u32 s49, s59
s_cselect_b32 s67, s71, 0
s_sub_u32 s49, s49, s67
s_add_u32 s48, s48, s51
s_mov_b32 s51, 0x1000
s_branch M1_PR0
M1_PF1:
buffer_load_dword v15, v14, s[28:31], s49 offen
s_add_u32 s49, s49, s50
s_cmp_ge_u32 s49, s59
s_cselect_b32 s67, s71, 0
s_sub_u32 s49, s49, s67
s_add_u32 s48, s48, s51
s_mov_b32 s51, 0x1000
s_branch M1_PR1
M1_PF2:
buffer_load_dword v15, v14, s[28:31], s49 offen
s_add_u32 s49, s49, s50
s_cmp_ge_u32 s49, s59
s_cselect_b32 s67, s71, 0
s_sub_u32 s49, s49, s67
s_add_u32 s48, s48, s51
s_mov_b32 s51, 0x1000
s_branch M1_PR2
M1_PF3:
buffer_load_dword v15, v14, s[28:31], s49 offen
s_add_u32 s49, s49, s50
s_cmp_ge_u32 s49, s59
s_cselect_b32 s67, s71, 0
s_sub_u32 s49, s49, s67
s_add_u32 s48, s48, s51
s_mov_b32 s51, 0x1000
s_branch M1_PR3
M1_STR:
s_add_u32 s57, s57, 1
s_cmp_gt_u32 s57, 100000
s_cbranch_scc1 M1_STOK
s_sleep 8
buffer_load_dwordx2 v[26:27], v25, s[36:39], s56 offen offset:0 sc0 sc1
buffer_load_dwordx2 v[28:29], v25, s[36:39], s56 offen offset:256 sc0 sc1
s_waitcnt vmcnt(0)
s_branch M1_STC
MT:
s_nop 1
v_lshrrev_b32 v9, 5, v1
v_bfe_u32 v10, v1, 4, 1
v_bfe_u32 v11, v1, 2, 2
v_bfe_u32 v12, v1, 1, 1
v_and_b32 v13, 1, v1
v_lshl_add_u32 v14, v9, 2, v11
v_lshlrev_b32 v14, 7, v14
v_lshl_add_u32 v15, v10, 1, v12
v_lshrrev_b32 v11, 1, v11
v_lshl_add_u32 v15, v11, 2, v15
v_lshl_add_u32 v14, v15, 4, v14
v_lshl_add_u32 v14, v13, 3, v14
v_add_u32 v16, s69, v14
v_xor_b32 v17, 64, v16
v_add_u32 v18, 0x10000, v16
v_add_u32 v19, 0x10000, v17
v_add_u32 v20, 147456, v16
v_add_u32 v21, 147456, v17
s_mov_b32 s28, s18
s_mov_b32 s29, s19
s_mov_b32 s30, 2097152
s_mov_b32 s31, 0x00020000
s_lshr_b32 s67, s60, 2
s_lshl_b32 s68, s48, 1
s_add_u32 s68, s68, s67
s_lshl_b32 s68, s68, 15
s_and_b32 s67, s60, 3
s_lshl_b32 s67, s67, 5
s_add_u32 s68, s68, s67
s_lshl_b32 s67, s49, 7
s_add_u32 s71, s68, s67
v_and_b32 v10, 31, v1
v_lshlrev_b32 v10, 10, v10
v_lshl_add_u32 v22, v9, 3, v10
v_lshl_add_u32 v23, v9, 4, v10
buffer_load_dwordx2 v[56:57], v22, s[24:27], s71 offen offset:0
buffer_load_dwordx2 v[58:59], v22, s[24:27], s71 offen offset:16
v_add_u32 v15, 147456, v8
v_mov_b64 v[64:65], 0
v_mov_b64 v[66:67], 0
v_mov_b64 v[68:69], 0
v_mov_b64 v[70:71], 0
v_mov_b64 v[72:73], 0
v_mov_b64 v[74:75], 0
v_mov_b64 v[76:77], 0
v_mov_b64 v[78:79], 0
v_mov_b64 v[80:81], 0
v_mov_b64 v[82:83], 0
v_mov_b64 v[84:85], 0
v_mov_b64 v[86:87], 0
v_mov_b64 v[88:89], 0
v_mov_b64 v[90:91], 0
v_mov_b64 v[92:93], 0
v_mov_b64 v[94:95], 0
v_mov_b64 v[96:97], 0
v_mov_b64 v[98:99], 0
v_mov_b64 v[100:101], 0
v_mov_b64 v[102:103], 0
v_mov_b64 v[104:105], 0
v_mov_b64 v[106:107], 0
v_mov_b64 v[108:109], 0
v_mov_b64 v[110:111], 0
v_mov_b64 v[112:113], 0
v_mov_b64 v[114:115], 0
v_mov_b64 v[116:117], 0
v_mov_b64 v[118:119], 0
v_mov_b64 v[120:121], 0
v_mov_b64 v[122:123], 0
v_mov_b64 v[124:125], 0
v_mov_b64 v[126:127], 0
s_lshl_b32 s67, s63, 1
s_lshr_b32 s68, s65, 1
s_add_u32 s67, s67, s68
s_lshl_b32 s67, s67, 12
s_add_u32 s72, s67, 13631488
v_mov_b32 v13, s75
v_and_b32 v12, 7, v1
v_lshlrev_b32 v12, 9, v12
v_and_b32 v11, 8, v1
v_add_u32 v12, v12, v11
s_and_b32 s68, s60, 1
s_lshl_b32 s68, s68, 2
s_add_u32 s72, s72, s68
s_cmp_ge_u32 s64, 14
s_cbranch_scc1 MT2
s_lshl_b32 s67, s64, 3
s_add_u32 s67, s67, s72
s_mov_b64 exec, 0xff
s_waitcnt vmcnt(2)
buffer_store_dword v13, v12, s[36:39], s67 offen sc0 sc1
s_mov_b64 exec, -1
MT2:
s_branch JOIN
ATT:
v_lshrrev_b32 v9, 5, v1
s_lshl_b32 s70, s65, 5
v_and_b32 v22, 31, v1
v_add_u32 v22, s70, v22
v_add_u32 v23, 2, v22
v_mul_u32_u24 v23, 208, v23
v_lshl_add_u32 v23, v9, 4, v23
v_add_u32 v23, 114688, v23
s_lshl_b32 s70, s63, 2
s_add_u32 s70, s70, s65
s_mul_i32 s70, s70, 144
s_lshl_b32 s68, s64, 1
s_add_u32 s70, s70, s68
s_lshl_b32 s70, s70, 10
s_setprio 3
s_mov_b32 s67, 0
AQ:
ds_read_b32 v10, v21
s_add_u32 s67, s67, 1
s_waitcnt lgkmcnt(0)
v_cmp_gt_u32 vcc, 6, v10
s_cmp_gt_u32 s67, 200000
s_cbranch_vccz AQD
s_cbranch_scc1 AQD
s_sleep 1
s_branch AQ
AQD:
ds_read_b128 v[24:27], v23 offset:2912
ds_read_b128 v[28:31], v23 offset:2976
ds_read_b128 v[32:35], v23 offset:2560
ds_read_b128 v[36:39], v23 offset:2144
ds_read_b128 v[40:43], v23 offset:1728
ds_read_b128 v[44:47], v23 offset:1312
ds_read_b128 v[48:51], v23 offset:896
ds_read_b128 v[52:55], v23 offset:480
ds_read_b128 v[56:59], v23 offset:64
s_waitcnt lgkmcnt(7)
ds_read_b128 v[64:67], v23 offset:3040
v_dot2_f32_bf16 v96, v24, v28, 0
v_dot2_f32_bf16 v96, v25, v29, v96
v_dot2_f32_bf16 v96, v26, v30, v96
v_dot2_f32_bf16 v96, v27, v31, v96
s_waitcnt lgkmcnt(7)
ds_read_b128 v[68:71], v23 offset:2624
v_dot2_f32_bf16 v97, v24, v32, 0
v_dot2_f32_bf16 v97, v25, v33, v97
v_dot2_f32_bf16 v97, v26, v34, v97
v_dot2_f32_bf16 v97, v27, v35, v97
s_waitcnt lgkmcnt(7)
ds_read_b128 v[72:75], v23 offset:2208
v_dot2_f32_bf16 v98, v24, v36, 0
v_dot2_f32_bf16 v98, v25, v37, v98
v_dot2_f32_bf16 v98, v26, v38, v98
v_dot2_f32_bf16 v98, v27, v39, v98
s_waitcnt lgkmcnt(7)
ds_read_b128 v[76:79], v23 offset:1792
v_dot2_f32_bf16 v99, v24, v40, 0
v_dot2_f32_bf16 v99, v25, v41, v99
v_dot2_f32_bf16 v99, v26, v42, v99
v_dot2_f32_bf16 v99, v27, v43, v99
s_waitcnt lgkmcnt(7)
ds_read_b128 v[80:83], v23 offset:1376
v_dot2_f32_bf16 v100, v24, v44, 0
v_dot2_f32_bf16 v100, v25, v45, v100
v_dot2_f32_bf16 v100, v26, v46, v100
v_dot2_f32_bf16 v100, v27, v47, v100
s_waitcnt lgkmcnt(7)
ds_read_b128 v[84:87], v23 offset:960
v_dot2_f32_bf16 v101, v24, v48, 0
v_dot2_f32_bf16 v101, v25, v49, v101
v_dot2_f32_bf16 v101, v26, v50, v101
v_dot2_f32_bf16 v101, v27, v51, v101
s_waitcnt lgkmcnt(7)
ds_read_b128 v[88:91], v23 offset:544
v_dot2_f32_bf16 v102, v24, v52, 0
v_dot2_f32_bf16 v102, v25, v53, v102
v_dot2_f32_bf16 v102, v26, v54, v102
v_dot2_f32_bf16 v102, v27, v55, v102
s_waitcnt lgkmcnt(7)
ds_read_b128 v[92:95], v23 offset:128
v_dot2_f32_bf16 v103, v24, v56, 0
v_dot2_f32_bf16 v103, v25, v57, v103
v_dot2_f32_bf16 v103, v26, v58, v103
v_dot2_f32_bf16 v103, v27, v59, v103
ds_read_b128 v[152:155], v23 offset:2944
ds_read_b128 v[156:159], v23 offset:3008
ds_read_b128 v[160:163], v23 offset:2592
ds_read_b128 v[164:167], v23 offset:2176
ds_read_b128 v[168:171], v23 offset:1760
ds_read_b128 v[172:175], v23 offset:1344
ds_read_b128 v[176:179], v23 offset:928
ds_read_b128 v[180:183], v23 offset:512
ds_read_b128 v[184:187], v23 offset:96
s_waitcnt lgkmcnt(7)
ds_read_b128 v[192:195], v23 offset:3072
v_dot2_f32_bf16 v224, v152, v156, 0
v_dot2_f32_bf16 v224, v153, v157, v224
v_dot2_f32_bf16 v224, v154, v158, v224
v_dot2_f32_bf16 v224, v155, v159, v224
s_waitcnt lgkmcnt(7)
ds_read_b128 v[196:199], v23 offset:2656
v_dot2_f32_bf16 v225, v152, v160, 0
v_dot2_f32_bf16 v225, v153, v161, v225
v_dot2_f32_bf16 v225, v154, v162, v225
v_dot2_f32_bf16 v225, v155, v163, v225
s_waitcnt lgkmcnt(7)
ds_read_b128 v[200:203], v23 offset:2240
v_dot2_f32_bf16 v226, v152, v164, 0
v_dot2_f32_bf16 v226, v153, v165, v226
v_dot2_f32_bf16 v226, v154, v166, v226
v_dot2_f32_bf16 v226, v155, v167, v226
s_waitcnt lgkmcnt(7)
ds_read_b128 v[204:207], v23 offset:1824
v_dot2_f32_bf16 v227, v152, v168, 0
v_dot2_f32_bf16 v227, v153, v169, v227
v_dot2_f32_bf16 v227, v154, v170, v227
v_dot2_f32_bf16 v227, v155, v171, v227
s_waitcnt lgkmcnt(7)
ds_read_b128 v[208:211], v23 offset:1408
v_dot2_f32_bf16 v228, v152, v172, 0
v_dot2_f32_bf16 v228, v153, v173, v228
v_dot2_f32_bf16 v228, v154, v174, v228
v_dot2_f32_bf16 v228, v155, v175, v228
s_waitcnt lgkmcnt(7)
ds_read_b128 v[212:215], v23 offset:992
v_dot2_f32_bf16 v229, v152, v176, 0
v_dot2_f32_bf16 v229, v153, v177, v229
v_dot2_f32_bf16 v229, v154, v178, v229
v_dot2_f32_bf16 v229, v155, v179, v229
s_waitcnt lgkmcnt(7)
ds_read_b128 v[216:219], v23 offset:576
v_dot2_f32_bf16 v230, v152, v180, 0
v_dot2_f32_bf16 v230, v153, v181, v230
v_dot2_f32_bf16 v230, v154, v182, v230
v_dot2_f32_bf16 v230, v155, v183, v230
s_waitcnt lgkmcnt(7)
ds_read_b128 v[220:223], v23 offset:160
v_dot2_f32_bf16 v231, v152, v184, 0
v_dot2_f32_bf16 v231, v153, v185, v231
v_dot2_f32_bf16 v231, v154, v186, v231
v_dot2_f32_bf16 v231, v155, v187, v231
v_permlane32_swap_b32 v96, v97
v_permlane32_swap_b32 v224, v225
v_permlane32_swap_b32 v98, v99
v_permlane32_swap_b32 v226, v227
v_permlane32_swap_b32 v100, v101
v_permlane32_swap_b32 v228, v229
v_permlane32_swap_b32 v102, v103
v_permlane32_swap_b32 v230, v231
v_add_f32 v96, v96, v97
v_add_f32 v224, v224, v225
v_add_f32 v97, v98, v99
v_add_f32 v225, v226, v227
v_add_f32 v98, v100, v101
v_add_f32 v226, v228, v229
v_add_f32 v99, v102, v103
v_add_f32 v227, v230, v231
v_cvt_pk_bf16_f32 v100, v96, v97
v_cvt_pk_bf16_f32 v228, v224, v225
v_cvt_pk_bf16_f32 v101, v98, v99
v_cvt_pk_bf16_f32 v229, v226, v227
v_lshlrev_b32 v96, 16, v100
v_lshlrev_b32 v224, 16, v228
v_and_b32 v97, 0xffff0000, v100
v_and_b32 v225, 0xffff0000, v228
v_lshlrev_b32 v98, 16, v101
v_lshlrev_b32 v226, 16, v229
v_and_b32 v99, 0xffff0000, v101
v_and_b32 v227, 0xffff0000, v229
s_cmp_lg_u32 s63, 0
s_cbranch_scc1 NOMASK
v_mov_b32 v10, 0xf149f2ca
v_lshlrev_b32 v11, 1, v9
v_sub_u32 v11, v22, v11
v_cmp_gt_i32 vcc, 0, v11
s_nop 1
v_cndmask_b32 v96, v96, v10, vcc
v_cndmask_b32 v224, v224, v10, vcc
v_cmp_gt_i32 vcc, 4, v11
s_nop 1
v_cndmask_b32 v97, v97, v10, vcc
v_cndmask_b32 v225, v225, v10, vcc
v_cmp_gt_i32 vcc, 8, v11
s_nop 1
v_cndmask_b32 v98, v98, v10, vcc
v_cndmask_b32 v226, v226, v10, vcc
v_cmp_gt_i32 vcc, 12, v11
s_nop 1
v_cndmask_b32 v99, v99, v10, vcc
v_cndmask_b32 v227, v227, v10, vcc
s_nop 3
NOMASK:
s_nop 3
v_max3_f32 v10, v96, v97, v98
v_max3_f32 v12, v224, v225, v226
v_max_f32 v10, v10, v99
v_max_f32 v12, v12, v227
v_mov_b32 v11, v10
v_mov_b32 v13, v12
s_nop 0
v_permlane32_swap_b32 v10, v11
v_permlane32_swap_b32 v12, v13
v_max_f32 v10, v10, v11
v_max_f32 v12, v12, v13
v_sub_f32 v96, v96, v10
v_sub_f32 v224, v224, v12
v_sub_f32 v97, v97, v10
v_sub_f32 v225, v225, v12
v_sub_f32 v98, v98, v10
v_sub_f32 v226, v226, v12
v_sub_f32 v99, v99, v10
v_sub_f32 v227, v227, v12
v_mul_f32 v96, 0x3eb8aa3b, v96
v_mul_f32 v224, 0x3eb8aa3b, v224
v_mul_f32 v97, 0x3eb8aa3b, v97
v_mul_f32 v225, 0x3eb8aa3b, v225
v_mul_f32 v98, 0x3eb8aa3b, v98
v_mul_f32 v226, 0x3eb8aa3b, v226
v_mul_f32 v99, 0x3eb8aa3b, v99
v_mul_f32 v227, 0x3eb8aa3b, v227
v_exp_f32 v96, v96
v_exp_f32 v224, v224
v_exp_f32 v97, v97
v_exp_f32 v225, v225
v_exp_f32 v98, v98
v_exp_f32 v226, v226
v_exp_f32 v99, v99
v_exp_f32 v227, v227
v_add_f32 v10, v96, v97
v_add_f32 v12, v224, v225
v_add_f32 v11, v98, v99
v_add_f32 v13, v226, v227
v_add_f32 v10, v10, v11
v_add_f32 v12, v12, v13
v_mov_b32 v11, v10
v_mov_b32 v13, v12
s_nop 0
v_permlane32_swap_b32 v10, v11
v_permlane32_swap_b32 v12, v13
v_add_f32 v10, v10, v11
v_add_f32 v12, v12, v13
v_rcp_f32 v10, v10
v_rcp_f32 v12, v12
v_mul_f32 v96, v10, v96
v_mul_f32 v224, v12, v224
v_mul_f32 v97, v10, v97
v_mul_f32 v225, v12, v225
v_mul_f32 v98, v10, v98
v_mul_f32 v226, v12, v226
v_mul_f32 v99, v10, v99
v_mul_f32 v227, v12, v227
v_cvt_pk_bf16_f32 v104, v96, 0
v_cvt_pk_bf16_f32 v232, v224, 0
v_cvt_pk_bf16_f32 v108, v97, 0
v_cvt_pk_bf16_f32 v236, v225, 0
v_cvt_pk_bf16_f32 v112, v98, 0
v_cvt_pk_bf16_f32 v240, v226, 0
v_cvt_pk_bf16_f32 v116, v99, 0
v_cvt_pk_bf16_f32 v244, v227, 0
v_mov_b32 v106, v104
v_mov_b32 v234, v232
v_mov_b32 v110, v108
v_mov_b32 v238, v236
v_mov_b32 v114, v112
v_mov_b32 v242, v240
v_mov_b32 v118, v116
v_mov_b32 v246, v244
v_permlane32_swap_b32 v104, v106
v_permlane32_swap_b32 v232, v234
v_permlane32_swap_b32 v108, v110
v_permlane32_swap_b32 v236, v238
v_permlane32_swap_b32 v112, v114
v_permlane32_swap_b32 v240, v242
v_permlane32_swap_b32 v116, v118
v_permlane32_swap_b32 v244, v246
v_lshlrev_b32 v105, 16, v104
v_lshlrev_b32 v233, 16, v232
v_lshlrev_b32 v107, 16, v106
v_lshlrev_b32 v235, 16, v234
v_lshlrev_b32 v109, 16, v108
v_lshlrev_b32 v237, 16, v236
v_lshlrev_b32 v111, 16, v110
v_lshlrev_b32 v239, 16, v238
v_lshlrev_b32 v113, 16, v112
v_lshlrev_b32 v241, 16, v240
v_lshlrev_b32 v115, 16, v114
v_lshlrev_b32 v243, 16, v242
v_lshlrev_b32 v117, 16, v116
v_lshlrev_b32 v245, 16, v244
v_lshlrev_b32 v119, 16, v118
v_lshlrev_b32 v247, 16, v246
v_dot2_f32_bf16 v120, v64, v104, 0
v_dot2_f32_bf16 v121, v64, v105, 0
v_dot2_f32_bf16 v122, v65, v104, 0
v_dot2_f32_bf16 v123, v65, v105, 0
v_dot2_f32_bf16 v124, v66, v104, 0
v_dot2_f32_bf16 v125, v66, v105, 0
v_dot2_f32_bf16 v126, v67, v104, 0
v_dot2_f32_bf16 v127, v67, v105, 0
v_dot2_f32_bf16 v120, v68, v106, v120
v_dot2_f32_bf16 v121, v68, v107, v121
v_dot2_f32_bf16 v122, v69, v106, v122
v_dot2_f32_bf16 v123, v69, v107, v123
v_dot2_f32_bf16 v124, v70, v106, v124
v_dot2_f32_bf16 v125, v70, v107, v125
v_dot2_f32_bf16 v126, v71, v106, v126
v_dot2_f32_bf16 v127, v71, v107, v127
v_dot2_f32_bf16 v120, v72, v108, v120
v_dot2_f32_bf16 v121, v72, v109, v121
v_dot2_f32_bf16 v122, v73, v108, v122
v_dot2_f32_bf16 v123, v73, v109, v123
v_dot2_f32_bf16 v124, v74, v108, v124
v_dot2_f32_bf16 v125, v74, v109, v125
v_dot2_f32_bf16 v126, v75, v108, v126
v_dot2_f32_bf16 v127, v75, v109, v127
v_dot2_f32_bf16 v120, v76, v110, v120
v_dot2_f32_bf16 v121, v76, v111, v121
v_dot2_f32_bf16 v122, v77, v110, v122
v_dot2_f32_bf16 v123, v77, v111, v123
v_dot2_f32_bf16 v124, v78, v110, v124
v_dot2_f32_bf16 v125, v78, v111, v125
v_dot2_f32_bf16 v126, v79, v110, v126
v_dot2_f32_bf16 v127, v79, v111, v127
v_dot2_f32_bf16 v120, v80, v112, v120
v_dot2_f32_bf16 v121, v80, v113, v121
v_dot2_f32_bf16 v122, v81, v112, v122
v_dot2_f32_bf16 v123, v81, v113, v123
v_dot2_f32_bf16 v124, v82, v112, v124
v_dot2_f32_bf16 v125, v82, v113, v125
v_dot2_f32_bf16 v126, v83, v112, v126
v_dot2_f32_bf16 v127, v83, v113, v127
v_dot2_f32_bf16 v120, v84, v114, v120
v_dot2_f32_bf16 v121, v84, v115, v121
v_dot2_f32_bf16 v122, v85, v114, v122
v_dot2_f32_bf16 v123, v85, v115, v123
v_dot2_f32_bf16 v124, v86, v114, v124
v_dot2_f32_bf16 v125, v86, v115, v125
v_dot2_f32_bf16 v126, v87, v114, v126
v_dot2_f32_bf16 v127, v87, v115, v127
v_dot2_f32_bf16 v120, v88, v116, v120
v_dot2_f32_bf16 v121, v88, v117, v121
v_dot2_f32_bf16 v122, v89, v116, v122
v_dot2_f32_bf16 v123, v89, v117, v123
v_dot2_f32_bf16 v124, v90, v116, v124
v_dot2_f32_bf16 v125, v90, v117, v125
v_dot2_f32_bf16 v126, v91, v116, v126
v_dot2_f32_bf16 v127, v91, v117, v127
v_dot2_f32_bf16 v120, v92, v118, v120
v_dot2_f32_bf16 v121, v92, v119, v121
v_dot2_f32_bf16 v122, v93, v118, v122
v_dot2_f32_bf16 v123, v93, v119, v123
v_dot2_f32_bf16 v124, v94, v118, v124
v_dot2_f32_bf16 v125, v94, v119, v125
v_dot2_f32_bf16 v126, v95, v118, v126
v_dot2_f32_bf16 v127, v95, v119, v127
v_cvt_pk_bf16_f32 v24, v120, v121
v_cvt_pk_bf16_f32 v25, v122, v123
v_cvt_pk_bf16_f32 v26, v124, v125
v_cvt_pk_bf16_f32 v27, v126, v127
buffer_store_dwordx4 v[24:27], v8, s[36:39], s70 offen offset:0 sc0 sc1
s_waitcnt lgkmcnt(0)
v_dot2_f32_bf16 v248, v192, v232, 0
v_dot2_f32_bf16 v249, v192, v233, 0
v_dot2_f32_bf16 v250, v193, v232, 0
v_dot2_f32_bf16 v251, v193, v233, 0
v_dot2_f32_bf16 v252, v194, v232, 0
v_dot2_f32_bf16 v253, v194, v233, 0
v_dot2_f32_bf16 v254, v195, v232, 0
v_dot2_f32_bf16 v255, v195, v233, 0
v_dot2_f32_bf16 v248, v196, v234, v248
v_dot2_f32_bf16 v249, v196, v235, v249
v_dot2_f32_bf16 v250, v197, v234, v250
v_dot2_f32_bf16 v251, v197, v235, v251
v_dot2_f32_bf16 v252, v198, v234, v252
v_dot2_f32_bf16 v253, v198, v235, v253
v_dot2_f32_bf16 v254, v199, v234, v254
v_dot2_f32_bf16 v255, v199, v235, v255
v_dot2_f32_bf16 v248, v200, v236, v248
v_dot2_f32_bf16 v249, v200, v237, v249
v_dot2_f32_bf16 v250, v201, v236, v250
v_dot2_f32_bf16 v251, v201, v237, v251
v_dot2_f32_bf16 v252, v202, v236, v252
v_dot2_f32_bf16 v253, v202, v237, v253
v_dot2_f32_bf16 v254, v203, v236, v254
v_dot2_f32_bf16 v255, v203, v237, v255
v_dot2_f32_bf16 v248, v204, v238, v248
v_dot2_f32_bf16 v249, v204, v239, v249
v_dot2_f32_bf16 v250, v205, v238, v250
v_dot2_f32_bf16 v251, v205, v239, v251
v_dot2_f32_bf16 v252, v206, v238, v252
v_dot2_f32_bf16 v253, v206, v239, v253
v_dot2_f32_bf16 v254, v207, v238, v254
v_dot2_f32_bf16 v255, v207, v239, v255
v_dot2_f32_bf16 v248, v208, v240, v248
v_dot2_f32_bf16 v249, v208, v241, v249
v_dot2_f32_bf16 v250, v209, v240, v250
v_dot2_f32_bf16 v251, v209, v241, v251
v_dot2_f32_bf16 v252, v210, v240, v252
v_dot2_f32_bf16 v253, v210, v241, v253
v_dot2_f32_bf16 v254, v211, v240, v254
v_dot2_f32_bf16 v255, v211, v241, v255
v_dot2_f32_bf16 v248, v212, v242, v248
v_dot2_f32_bf16 v249, v212, v243, v249
v_dot2_f32_bf16 v250, v213, v242, v250
v_dot2_f32_bf16 v251, v213, v243, v251
v_dot2_f32_bf16 v252, v214, v242, v252
v_dot2_f32_bf16 v253, v214, v243, v253
v_dot2_f32_bf16 v254, v215, v242, v254
v_dot2_f32_bf16 v255, v215, v243, v255
v_dot2_f32_bf16 v248, v216, v244, v248
v_dot2_f32_bf16 v249, v216, v245, v249
v_dot2_f32_bf16 v250, v217, v244, v250
v_dot2_f32_bf16 v251, v217, v245, v251
v_dot2_f32_bf16 v252, v218, v244, v252
v_dot2_f32_bf16 v253, v218, v245, v253
v_dot2_f32_bf16 v254, v219, v244, v254
v_dot2_f32_bf16 v255, v219, v245, v255
v_dot2_f32_bf16 v248, v220, v246, v248
v_dot2_f32_bf16 v249, v220, v247, v249
v_dot2_f32_bf16 v250, v221, v246, v250
v_dot2_f32_bf16 v251, v221, v247, v251
v_dot2_f32_bf16 v252, v222, v246, v252
v_dot2_f32_bf16 v253, v222, v247, v253
v_dot2_f32_bf16 v254, v223, v246, v254
v_dot2_f32_bf16 v255, v223, v247, v255
v_cvt_pk_bf16_f32 v152, v248, v249
v_cvt_pk_bf16_f32 v153, v250, v251
v_cvt_pk_bf16_f32 v154, v252, v253
v_cvt_pk_bf16_f32 v155, v254, v255
buffer_store_dwordx4 v[152:155], v8, s[36:39], s70 offen offset:1024 sc0 sc1
s_setprio 0
v_lshrrev_b32 v9, 5, v1
v_bfe_u32 v10, v1, 4, 1
v_bfe_u32 v11, v1, 2, 2
v_bfe_u32 v12, v1, 1, 1
v_and_b32 v13, 1, v1
v_lshl_add_u32 v14, v9, 2, v11
v_lshlrev_b32 v14, 7, v14
v_lshl_add_u32 v15, v10, 1, v12
v_lshrrev_b32 v11, 1, v11
v_lshl_add_u32 v15, v11, 2, v15
v_lshl_add_u32 v14, v15, 4, v14
v_lshl_add_u32 v14, v13, 3, v14
v_add_u32 v16, s69, v14
v_xor_b32 v17, 64, v16
v_add_u32 v18, 0x10000, v16
v_add_u32 v19, 0x10000, v17
v_add_u32 v20, 147456, v16
v_add_u32 v21, 147456, v17
s_mov_b32 s28, s18
s_mov_b32 s29, s19
s_mov_b32 s30, 2097152
s_mov_b32 s31, 0x00020000
s_lshr_b32 s67, s60, 2
s_lshl_b32 s68, s48, 1
s_add_u32 s68, s68, s67
s_lshl_b32 s68, s68, 15
s_and_b32 s67, s60, 3
s_lshl_b32 s67, s67, 5
s_add_u32 s68, s68, s67
s_lshl_b32 s67, s49, 7
s_add_u32 s71, s68, s67
v_and_b32 v10, 31, v1
v_lshlrev_b32 v10, 10, v10
v_lshl_add_u32 v22, v9, 3, v10
v_lshl_add_u32 v23, v9, 4, v10
buffer_load_dwordx2 v[56:57], v22, s[24:27], s71 offen offset:0
buffer_load_dwordx2 v[58:59], v22, s[24:27], s71 offen offset:16
v_add_u32 v15, 147456, v8
v_mov_b64 v[64:65], 0
v_mov_b64 v[66:67], 0
v_mov_b64 v[68:69], 0
v_mov_b64 v[70:71], 0
v_mov_b64 v[72:73], 0
v_mov_b64 v[74:75], 0
v_mov_b64 v[76:77], 0
v_mov_b64 v[78:79], 0
v_mov_b64 v[80:81], 0
v_mov_b64 v[82:83], 0
v_mov_b64 v[84:85], 0
v_mov_b64 v[86:87], 0
v_mov_b64 v[88:89], 0
v_mov_b64 v[90:91], 0
v_mov_b64 v[92:93], 0
v_mov_b64 v[94:95], 0
v_mov_b64 v[96:97], 0
v_mov_b64 v[98:99], 0
v_mov_b64 v[100:101], 0
v_mov_b64 v[102:103], 0
v_mov_b64 v[104:105], 0
v_mov_b64 v[106:107], 0
v_mov_b64 v[108:109], 0
v_mov_b64 v[110:111], 0
v_mov_b64 v[112:113], 0
v_mov_b64 v[114:115], 0
v_mov_b64 v[116:117], 0
v_mov_b64 v[118:119], 0
v_mov_b64 v[120:121], 0
v_mov_b64 v[122:123], 0
v_mov_b64 v[124:125], 0
v_mov_b64 v[126:127], 0
s_lshl_b32 s67, s63, 1
s_lshr_b32 s68, s65, 1
s_add_u32 s67, s67, s68
s_lshl_b32 s67, s67, 12
s_add_u32 s72, s67, 13631488
v_mov_b32 v13, s75
v_and_b32 v12, 7, v1
v_lshlrev_b32 v12, 9, v12
v_and_b32 v11, 8, v1
v_add_u32 v12, v12, v11
s_and_b32 s68, s60, 1
s_lshl_b32 s68, s68, 2
s_add_u32 s72, s72, s68
s_lshl_b32 s67, s64, 4
s_add_u32 s67, s67, s72
s_mov_b64 exec, 0xffff
s_waitcnt vmcnt(2)
buffer_store_dword v13, v12, s[36:39], s67 offen offset:256 sc0 sc1
s_mov_b64 exec, -1
JOIN:
s_lshl_b32 s72, s48, 1
s_lshr_b32 s68, s60, 2
s_add_u32 s72, s72, s68
s_lshl_b32 s72, s72, 8
s_add_u32 s72, s72, 10485760
v_and_b32 v61, 31, v1
v_lshlrev_b32 v61, 3, v61
s_barrier
ds_read_b64_tr_b16 v[128:129], v20 offset:0
ds_read_b64_tr_b16 v[130:131], v20 offset:1024
ds_read_b64_tr_b16 v[132:133], v21 offset:0
ds_read_b64_tr_b16 v[134:135], v21 offset:1024
ds_read_b64_tr_b16 v[136:137], v16 offset:0
ds_read_b64_tr_b16 v[138:139], v16 offset:1024
ds_read_b64_tr_b16 v[140:141], v17 offset:0
ds_read_b64_tr_b16 v[142:143], v17 offset:1024
ds_read_b64_tr_b16 v[144:145], v16 offset:16384
ds_read_b64_tr_b16 v[146:147], v16 offset:17408
ds_read_b64_tr_b16 v[148:149], v17 offset:16384
ds_read_b64_tr_b16 v[150:151], v17 offset:17408
ds_read_b64_tr_b16 v[152:153], v16 offset:32768
ds_read_b64_tr_b16 v[154:155], v16 offset:33792
ds_read_b64_tr_b16 v[156:157], v17 offset:32768
ds_read_b64_tr_b16 v[158:159], v17 offset:33792
ds_read_b64_tr_b16 v[160:161], v16 offset:49152
ds_read_b64_tr_b16 v[162:163], v16 offset:50176
ds_read_b64_tr_b16 v[164:165], v17 offset:49152
ds_read_b64_tr_b16 v[166:167], v17 offset:50176
ds_read_b64_tr_b16 v[168:169], v18 offset:0
ds_read_b64_tr_b16 v[170:171], v18 offset:1024
ds_read_b64_tr_b16 v[172:173], v19 offset:0
ds_read_b64_tr_b16 v[174:175], v19 offset:1024
ds_read_b64_tr_b16 v[176:177], v18 offset:16384
ds_read_b64_tr_b16 v[178:179], v18 offset:17408
ds_read_b64_tr_b16 v[180:181], v19 offset:16384
ds_read_b64_tr_b16 v[182:183], v19 offset:17408
ds_read_b64_tr_b16 v[184:185], v18 offset:32768
ds_read_b64_tr_b16 v[186:187], v18 offset:33792
ds_read_b64_tr_b16 v[188:189], v19 offset:32768
ds_read_b64_tr_b16 v[190:191], v19 offset:33792
s_waitcnt lgkmcnt(15)
s_add_u32 m0, s69, 147456
s_nop 0
buffer_load_dwordx4 v2, s[44:47], s73 offen lds
s_add_u32 s73, s73, 8192
s_add_u32 m0, s69, 148480
s_nop 0
buffer_load_dwordx4 v2, s[44:47], s73 offen lds
s_add_u32 s73, s73, 8192
s_add_u32 m0, s69, 0
s_nop 0
buffer_load_dwordx4 v2, s[44:47], s73 offen lds
s_add_u32 s73, s73, 8192
s_add_u32 m0, s69, 1024
s_nop 0
buffer_load_dwordx4 v2, s[44:47], s73 offen lds
s_add_u32 s73, s73, 8192
s_add_u32 m0, s69, 16384
s_nop 0
buffer_load_dwordx4 v2, s[44:47], s73 offen lds
s_add_u32 s73, s73, 8192
s_add_u32 m0, s69, 17408
s_nop 0
buffer_load_dwordx4 v2, s[44:47], s73 offen lds
s_add_u32 s73, s73, 8192
s_add_u32 m0, s69, 32768
s_nop 0
buffer_load_dwordx4 v2, s[44:47], s73 offen lds
s_add_u32 s73, s73, 8192
s_add_u32 m0, s69, 33792
s_nop 0
buffer_load_dwordx4 v2, s[44:47], s73 offen lds
s_add_u32 s73, s73, 8192
s_waitcnt lgkmcnt(12)
s_add_u32 m0, s69, 49152
s_nop 0
buffer_load_dwordx4 v2, s[44:47], s73 offen lds
s_add_u32 s73, s73, 8192
s_add_u32 m0, s69, 50176
s_nop 0
buffer_load_dwordx4 v2, s[44:47], s73 offen lds
s_add_u32 s73, s73, 8192
s_waitcnt lgkmcnt(8)
s_add_u32 m0, s69, 65536
s_nop 0
buffer_load_dwordx4 v2, s[44:47], s73 offen lds
s_add_u32 s73, s73, 8192
s_add_u32 m0, s69, 66560
s_nop 0
buffer_load_dwordx4 v2, s[44:47], s73 offen lds
s_add_u32 s73, s73, 8192
s_waitcnt lgkmcnt(4)
s_add_u32 m0, s69, 81920
s_nop 0
buffer_load_dwordx4 v2, s[44:47], s73 offen lds
s_add_u32 s73, s73, 8192
s_add_u32 m0, s69, 82944
s_nop 0
buffer_load_dwordx4 v2, s[44:47], s73 offen lds
s_add_u32 s73, s73, 8192
s_waitcnt lgkmcnt(0)
s_add_u32 m0, s69, 98304
s_nop 0
buffer_load_dwordx4 v2, s[44:47], s73 offen lds
s_add_u32 s73, s73, 8192
s_add_u32 m0, s69, 99328
s_nop 0
buffer_load_dwordx4 v2, s[44:47], s73 offen lds
s_add_u32 s73, s73, 8192
NOW2:
s_waitcnt lgkmcnt(0)
s_lshl_b32 s67, s48, 3
s_add_u32 s67, s67, s49
s_lshl_b32 s67, s67, 9
s_add_u32 s67, s67, 13631488
v_lshlrev_b32 v9, 2, v1
s_mov_b32 s68, 0
s_lshr_b32 s70, s52, 3
s_lshl_b32 s70, s70, 1
s_lshl_b32 s54, 0x3f, s70
s_mov_b32 s55, 0
s_cmp_lt_u32 s60, 6
s_cbranch_scc1 POLL0
s_add_u32 s67, s67, 256
s_cmp_eq_u32 s60, 6
s_cselect_b32 s54, -1, 0
s_cselect_b32 s55, 0, -1
POLL0:
s_mov_b64 exec, s[54:55]
POLL:
buffer_load_dword v10, v9, s[36:39], s67 offen sc0 sc1
s_add_u32 s68, s68, 1
s_waitcnt vmcnt(0)
v_cmp_ne_u32 vcc, s75, v10
s_cmp_gt_u32 s68, 100000
s_cbranch_vccz POLLE
s_cbranch_scc1 POLLE
s_sleep 2
s_branch POLL
POLLE:
s_mov_b64 exec, -1
POLLD:
buffer_load_dwordx4 v[192:195], v8, s[36:39], s74 offen offset:0
buffer_load_dwordx4 v[196:199], v15, s[36:39], s74 offen offset:0
buffer_load_dwordx4 v[200:203], v8, s[36:39], s74 offen offset:1024
buffer_load_dwordx4 v[204:207], v15, s[36:39], s74 offen offset:1024
buffer_load_dwordx4 v[208:211], v8, s[36:39], s74 offen offset:2048
buffer_load_dwordx4 v[212:215], v15, s[36:39], s74 offen offset:2048
buffer_load_dwordx4 v[216:219], v8, s[36:39], s74 offen offset:3072
buffer_load_dwordx4 v[220:223], v15, s[36:39], s74 offen offset:3072
s_add_u32 s74, s74, 4096
buffer_load_dwordx4 v[224:227], v8, s[36:39], s74 offen offset:0
buffer_load_dwordx4 v[228:231], v15, s[36:39], s74 offen offset:0
buffer_load_dwordx4 v[232:235], v8, s[36:39], s74 offen offset:1024
buffer_load_dwordx4 v[236:239], v15, s[36:39], s74 offen offset:1024
buffer_load_dwordx4 v[240:243], v8, s[36:39], s74 offen offset:2048
buffer_load_dwordx4 v[244:247], v15, s[36:39], s74 offen offset:2048
buffer_load_dwordx4 v[248:251], v8, s[36:39], s74 offen offset:3072
buffer_load_dwordx4 v[252:255], v15, s[36:39], s74 offen offset:3072
s_add_u32 s74, s74, 4096
buffer_load_dword v60, v61, s[36:39], s72 offen sc0 sc1
s_waitcnt vmcnt(15)
v_mfma_f32_32x32x16_bf16 v[64:79], v[128:131], v[192:195], v[64:79]
v_mfma_f32_32x32x16_bf16 v[80:95], v[132:135], v[192:195], v[80:95]
v_mfma_f32_32x32x16_bf16 v[96:111], v[128:131], v[196:199], v[96:111]
v_mfma_f32_32x32x16_bf16 v[112:127], v[132:135], v[196:199], v[112:127]
buffer_load_dwordx4 v[192:195], v8, s[36:39], s74 offen offset:0
buffer_load_dwordx4 v[196:199], v15, s[36:39], s74 offen offset:0
s_waitcnt vmcnt(15)
v_mfma_f32_32x32x16_bf16 v[64:79], v[136:139], v[200:203], v[64:79]
v_mfma_f32_32x32x16_bf16 v[80:95], v[140:143], v[200:203], v[80:95]
v_mfma_f32_32x32x16_bf16 v[96:111], v[136:139], v[204:207], v[96:111]
v_mfma_f32_32x32x16_bf16 v[112:127], v[140:143], v[204:207], v[112:127]
buffer_load_dwordx4 v[200:203], v8, s[36:39], s74 offen offset:1024
buffer_load_dwordx4 v[204:207], v15, s[36:39], s74 offen offset:1024
s_waitcnt vmcnt(15)
v_mfma_f32_32x32x16_bf16 v[64:79], v[144:147], v[208:211], v[64:79]
v_mfma_f32_32x32x16_bf16 v[80:95], v[148:151], v[208:211], v[80:95]
v_mfma_f32_32x32x16_bf16 v[96:111], v[144:147], v[212:215], v[96:111]
v_mfma_f32_32x32x16_bf16 v[112:127], v[148:151], v[212:215], v[112:127]
buffer_load_dwordx4 v[208:211], v8, s[36:39], s74 offen offset:2048
buffer_load_dwordx4 v[212:215], v15, s[36:39], s74 offen offset:2048
s_waitcnt vmcnt(15)
v_mfma_f32_32x32x16_bf16 v[64:79], v[152:155], v[216:219], v[64:79]
v_mfma_f32_32x32x16_bf16 v[80:95], v[156:159], v[216:219], v[80:95]
v_mfma_f32_32x32x16_bf16 v[96:111], v[152:155], v[220:223], v[96:111]
v_mfma_f32_32x32x16_bf16 v[112:127], v[156:159], v[220:223], v[112:127]
buffer_load_dwordx4 v[216:219], v8, s[36:39], s74 offen offset:3072
buffer_load_dwordx4 v[220:223], v15, s[36:39], s74 offen offset:3072
s_add_u32 s74, s74, 4096
s_waitcnt vmcnt(15)
v_mfma_f32_32x32x16_bf16 v[64:79], v[160:163], v[224:227], v[64:79]
v_mfma_f32_32x32x16_bf16 v[80:95], v[164:167], v[224:227], v[80:95]
v_mfma_f32_32x32x16_bf16 v[96:111], v[160:163], v[228:231], v[96:111]
v_mfma_f32_32x32x16_bf16 v[112:127], v[164:167], v[228:231], v[112:127]
buffer_load_dwordx4 v[224:227], v8, s[36:39], s74 offen offset:0
buffer_load_dwordx4 v[228:231], v15, s[36:39], s74 offen offset:0
s_waitcnt vmcnt(15)
v_mfma_f32_32x32x16_bf16 v[64:79], v[168:171], v[232:235], v[64:79]
v_mfma_f32_32x32x16_bf16 v[80:95], v[172:175], v[232:235], v[80:95]
v_mfma_f32_32x32x16_bf16 v[96:111], v[168:171], v[236:239], v[96:111]
v_mfma_f32_32x32x16_bf16 v[112:127], v[172:175], v[236:239], v[112:127]
buffer_load_dwordx4 v[232:235], v8, s[36:39], s74 offen offset:1024
buffer_load_dwordx4 v[236:239], v15, s[36:39], s74 offen offset:1024
s_waitcnt vmcnt(15)
v_mfma_f32_32x32x16_bf16 v[64:79], v[176:179], v[240:243], v[64:79]
v_mfma_f32_32x32x16_bf16 v[80:95], v[180:183], v[240:243], v[80:95]
v_mfma_f32_32x32x16_bf16 v[96:111], v[176:179], v[244:247], v[96:111]
v_mfma_f32_32x32x16_bf16 v[112:127], v[180:183], v[244:247], v[112:127]
buffer_load_dwordx4 v[240:243], v8, s[36:39], s74 offen offset:2048
buffer_load_dwordx4 v[244:247], v15, s[36:39], s74 offen offset:2048
ds_read_b64_tr_b16 v[24:25], v20 offset:0
ds_read_b64_tr_b16 v[26:27], v20 offset:1024
ds_read_b64_tr_b16 v[28:29], v21 offset:0
ds_read_b64_tr_b16 v[30:31], v21 offset:1024
s_waitcnt vmcnt(15)
v_mfma_f32_32x32x16_bf16 v[64:79], v[184:187], v[248:251], v[64:79]
v_mfma_f32_32x32x16_bf16 v[80:95], v[188:191], v[248:251], v[80:95]
v_mfma_f32_32x32x16_bf16 v[96:111], v[184:187], v[252:255], v[96:111]
v_mfma_f32_32x32x16_bf16 v[112:127], v[188:191], v[252:255], v[112:127]
buffer_load_dwordx4 v[248:251], v8, s[36:39], s74 offen offset:3072
buffer_load_dwordx4 v[252:255], v15, s[36:39], s74 offen offset:3072
s_add_u32 s74, s74, 4096
ds_read_b64_tr_b16 v[32:33], v16 offset:0
ds_read_b64_tr_b16 v[34:35], v16 offset:1024
ds_read_b64_tr_b16 v[36:37], v17 offset:0
ds_read_b64_tr_b16 v[38:39], v17 offset:1024
s_waitcnt vmcnt(14) lgkmcnt(4)
s_cmp_gt_u32 s51, 16
s_cselect_b32 s67, s73, 0
s_cselect_b32 s68, 8192, 0
s_add_u32 m0, s69, 147456
s_nop 0
buffer_load_dwordx4 v2, s[44:47], s67 offen lds
s_add_u32 s67, s67, s68
s_add_u32 s73, s73, 8192
s_add_u32 m0, s69, 148480
s_nop 0
buffer_load_dwordx4 v2, s[44:47], s67 offen lds
s_add_u32 s73, s73, 8192
v_mfma_f32_32x32x16_bf16 v[64:79], v[24:27], v[192:195], v[64:79]
v_mfma_f32_32x32x16_bf16 v[80:95], v[28:31], v[192:195], v[80:95]
v_mfma_f32_32x32x16_bf16 v[96:111], v[24:27], v[196:199], v[96:111]
v_mfma_f32_32x32x16_bf16 v[112:127], v[28:31], v[196:199], v[112:127]
s_cmp_gt_u32 s51, 16
s_cselect_b32 s70, s74, 12582912
buffer_load_dwordx4 v[192:195], v8, s[36:39], s70 offen offset:0
buffer_load_dwordx4 v[196:199], v15, s[36:39], s70 offen offset:0
ds_read_b64_tr_b16 v[24:25], v16 offset:16384
ds_read_b64_tr_b16 v[26:27], v16 offset:17408
ds_read_b64_tr_b16 v[28:29], v17 offset:16384
ds_read_b64_tr_b16 v[30:31], v17 offset:17408
s_waitcnt vmcnt(16) lgkmcnt(4)
s_cmp_gt_u32 s51, 17
s_cselect_b32 s67, s73, 0
s_cselect_b32 s68, 8192, 0
s_add_u32 m0, s69, 0
s_nop 0
buffer_load_dwordx4 v2, s[44:47], s67 offen lds
s_add_u32 s67, s67, s68
s_add_u32 s73, s73, 8192
s_add_u32 m0, s69, 1024
s_nop 0
buffer_load_dwordx4 v2, s[44:47], s67 offen lds
s_add_u32 s73, s73, 8192
v_mfma_f32_32x32x16_bf16 v[64:79], v[32:35], v[200:203], v[64:79]
v_mfma_f32_32x32x16_bf16 v[80:95], v[36:39], v[200:203], v[80:95]
v_mfma_f32_32x32x16_bf16 v[96:111], v[32:35], v[204:207], v[96:111]
v_mfma_f32_32x32x16_bf16 v[112:127], v[36:39], v[204:207], v[112:127]
s_cmp_gt_u32 s51, 17
s_cselect_b32 s70, s74, 12582912
buffer_load_dwordx4 v[200:203], v8, s[36:39], s70 offen offset:1024
buffer_load_dwordx4 v[204:207], v15, s[36:39], s70 offen offset:1024
ds_read_b64_tr_b16 v[32:33], v16 offset:32768
ds_read_b64_tr_b16 v[34:35], v16 offset:33792
ds_read_b64_tr_b16 v[36:37], v17 offset:32768
ds_read_b64_tr_b16 v[38:39], v17 offset:33792
s_waitcnt vmcnt(18) lgkmcnt(4)
s_cmp_gt_u32 s51, 18
s_cselect_b32 s67, s73, 0
s_cselect_b32 s68, 8192, 0
s_add_u32 m0, s69, 16384
s_nop 0
buffer_load_dwordx4 v2, s[44:47], s67 offen lds
s_add_u32 s67, s67, s68
s_add_u32 s73, s73, 8192
s_add_u32 m0, s69, 17408
s_nop 0
buffer_load_dwordx4 v2, s[44:47], s67 offen lds
s_add_u32 s73, s73, 8192
v_mfma_f32_32x32x16_bf16 v[64:79], v[24:27], v[208:211], v[64:79]
v_mfma_f32_32x32x16_bf16 v[80:95], v[28:31], v[208:211], v[80:95]
v_mfma_f32_32x32x16_bf16 v[96:111], v[24:27], v[212:215], v[96:111]
v_mfma_f32_32x32x16_bf16 v[112:127], v[28:31], v[212:215], v[112:127]
s_cmp_gt_u32 s51, 18
s_cselect_b32 s70, s74, 12582912
buffer_load_dwordx4 v[208:211], v8, s[36:39], s70 offen offset:2048
buffer_load_dwordx4 v[212:215], v15, s[36:39], s70 offen offset:2048
ds_read_b64_tr_b16 v[24:25], v16 offset:49152
ds_read_b64_tr_b16 v[26:27], v16 offset:50176
ds_read_b64_tr_b16 v[28:29], v17 offset:49152
ds_read_b64_tr_b16 v[30:31], v17 offset:50176
s_waitcnt vmcnt(20) lgkmcnt(4)
s_cmp_gt_u32 s51, 19
s_cselect_b32 s67, s73, 0
s_cselect_b32 s68, 8192, 0
s_add_u32 m0, s69, 32768
s_nop 0
buffer_load_dwordx4 v2, s[44:47], s67 offen lds
s_add_u32 s67, s67, s68
s_add_u32 s73, s73, 8192
s_add_u32 m0, s69, 33792
s_nop 0
buffer_load_dwordx4 v2, s[44:47], s67 offen lds
s_add_u32 s73, s73, 8192
v_mfma_f32_32x32x16_bf16 v[64:79], v[32:35], v[216:219], v[64:79]
v_mfma_f32_32x32x16_bf16 v[80:95], v[36:39], v[216:219], v[80:95]
v_mfma_f32_32x32x16_bf16 v[96:111], v[32:35], v[220:223], v[96:111]
v_mfma_f32_32x32x16_bf16 v[112:127], v[36:39], v[220:223], v[112:127]
s_cmp_gt_u32 s51, 19
s_cselect_b32 s70, s74, 12582912
buffer_load_dwordx4 v[216:219], v8, s[36:39], s70 offen offset:3072
buffer_load_dwordx4 v[220:223], v15, s[36:39], s70 offen offset:3072
s_add_u32 s74, s74, 4096
ds_read_b64_tr_b16 v[32:33], v18 offset:0
ds_read_b64_tr_b16 v[34:35], v18 offset:1024
ds_read_b64_tr_b16 v[36:37], v19 offset:0
ds_read_b64_tr_b16 v[38:39], v19 offset:1024
s_waitcnt vmcnt(22) lgkmcnt(4)
v_mfma_f32_32x32x16_bf16 v[64:79], v[24:27], v[224:227], v[64:79]
v_mfma_f32_32x32x16_bf16 v[80:95], v[28:31], v[224:227], v[80:95]
v_mfma_f32_32x32x16_bf16 v[96:111], v[24:27], v[228:231], v[96:111]
v_mfma_f32_32x32x16_bf16 v[112:127], v[28:31], v[228:231], v[112:127]
ds_read_b64_tr_b16 v[24:25], v18 offset:16384
ds_read_b64_tr_b16 v[26:27], v18 offset:17408
ds_read_b64_tr_b16 v[28:29], v19 offset:16384
ds_read_b64_tr_b16 v[30:31], v19 offset:17408
s_waitcnt vmcnt(20) lgkmcnt(4)
v_mfma_f32_32x32x16_bf16 v[64:79], v[32:35], v[232:235], v[64:79]
v_mfma_f32_32x32x16_bf16 v[80:95], v[36:39], v[232:235], v[80:95]
v_mfma_f32_32x32x16_bf16 v[96:111], v[32:35], v[236:239], v[96:111]
v_mfma_f32_32x32x16_bf16 v[112:127], v[36:39], v[236:239], v[112:127]
ds_read_b64_tr_b16 v[32:33], v18 offset:32768
ds_read_b64_tr_b16 v[34:35], v18 offset:33792
ds_read_b64_tr_b16 v[36:37], v19 offset:32768
ds_read_b64_tr_b16 v[38:39], v19 offset:33792
s_waitcnt vmcnt(18) lgkmcnt(4)
v_mfma_f32_32x32x16_bf16 v[64:79], v[24:27], v[240:243], v[64:79]
v_mfma_f32_32x32x16_bf16 v[80:95], v[28:31], v[240:243], v[80:95]
v_mfma_f32_32x32x16_bf16 v[96:111], v[24:27], v[244:247], v[96:111]
v_mfma_f32_32x32x16_bf16 v[112:127], v[28:31], v[244:247], v[112:127]
s_waitcnt vmcnt(14)
ds_read_b64_tr_b16 v[24:25], v20 offset:0
ds_read_b64_tr_b16 v[26:27], v20 offset:1024
ds_read_b64_tr_b16 v[28:29], v21 offset:0
ds_read_b64_tr_b16 v[30:31], v21 offset:1024
s_waitcnt lgkmcnt(4)
v_mfma_f32_32x32x16_bf16 v[64:79], v[32:35], v[248:251], v[64:79]
v_mfma_f32_32x32x16_bf16 v[80:95], v[36:39], v[248:251], v[80:95]
v_mfma_f32_32x32x16_bf16 v[96:111], v[32:35], v[252:255], v[96:111]
v_mfma_f32_32x32x16_bf16 v[112:127], v[36:39], v[252:255], v[112:127]
s_cmp_eq_u32 s51, 16
s_cbranch_scc1 RED
s_waitcnt vmcnt(10)
ds_read_b64_tr_b16 v[32:33], v16 offset:0
ds_read_b64_tr_b16 v[34:35], v16 offset:1024
ds_read_b64_tr_b16 v[36:37], v17 offset:0
ds_read_b64_tr_b16 v[38:39], v17 offset:1024
s_waitcnt lgkmcnt(4)
v_mfma_f32_32x32x16_bf16 v[64:79], v[24:27], v[192:195], v[64:79]
v_mfma_f32_32x32x16_bf16 v[80:95], v[28:31], v[192:195], v[80:95]
v_mfma_f32_32x32x16_bf16 v[96:111], v[24:27], v[196:199], v[96:111]
v_mfma_f32_32x32x16_bf16 v[112:127], v[28:31], v[196:199], v[112:127]
s_waitcnt vmcnt(6)
ds_read_b64_tr_b16 v[24:25], v16 offset:16384
ds_read_b64_tr_b16 v[26:27], v16 offset:17408
ds_read_b64_tr_b16 v[28:29], v17 offset:16384
ds_read_b64_tr_b16 v[30:31], v17 offset:17408
s_waitcnt lgkmcnt(4)
v_mfma_f32_32x32x16_bf16 v[64:79], v[32:35], v[200:203], v[64:79]
v_mfma_f32_32x32x16_bf16 v[80:95], v[36:39], v[200:203], v[80:95]
v_mfma_f32_32x32x16_bf16 v[96:111], v[32:35], v[204:207], v[96:111]
v_mfma_f32_32x32x16_bf16 v[112:127], v[36:39], v[204:207], v[112:127]
s_cmp_eq_u32 s51, 18
s_cbranch_scc1 RED
s_waitcnt vmcnt(2)
ds_read_b64_tr_b16 v[32:33], v16 offset:32768
ds_read_b64_tr_b16 v[34:35], v16 offset:33792
ds_read_b64_tr_b16 v[36:37], v17 offset:32768
ds_read_b64_tr_b16 v[38:39], v17 offset:33792
s_waitcnt lgkmcnt(4)
v_mfma_f32_32x32x16_bf16 v[64:79], v[24:27], v[208:211], v[64:79]
v_mfma_f32_32x32x16_bf16 v[80:95], v[28:31], v[208:211], v[80:95]
v_mfma_f32_32x32x16_bf16 v[96:111], v[24:27], v[212:215], v[96:111]
v_mfma_f32_32x32x16_bf16 v[112:127], v[28:31], v[212:215], v[112:127]
s_waitcnt vmcnt(0) lgkmcnt(0)
v_mfma_f32_32x32x16_bf16 v[64:79], v[32:35], v[216:219], v[64:79]
v_mfma_f32_32x32x16_bf16 v[80:95], v[36:39], v[216:219], v[80:95]
v_mfma_f32_32x32x16_bf16 v[96:111], v[32:35], v[220:223], v[96:111]
v_mfma_f32_32x32x16_bf16 v[112:127], v[36:39], v[220:223], v[112:127]
RED:
s_waitcnt vmcnt(0) lgkmcnt(0)
s_nop 7
s_nop 7
v_add_u32 v16, s69, v8
v_add_u32 v18, 0x10000, v16
v_add_u32 v20, 147456, v16
ds_write_b128 v16, v[64:67] offset:0
ds_write_b128 v16, v[68:71] offset:1024
ds_write_b128 v16, v[72:75] offset:16384
ds_write_b128 v16, v[76:79] offset:17408
ds_write_b128 v16, v[80:83] offset:32768
ds_write_b128 v16, v[84:87] offset:33792
ds_write_b128 v16, v[88:91] offset:49152
ds_write_b128 v16, v[92:95] offset:50176
ds_write_b128 v18, v[96:99] offset:0
ds_write_b128 v18, v[100:103] offset:1024
ds_write_b128 v18, v[104:107] offset:16384
ds_write_b128 v18, v[108:111] offset:17408
ds_write_b128 v18, v[112:115] offset:32768
ds_write_b128 v18, v[116:119] offset:33792
ds_write_b128 v20, v[120:123] offset:0
ds_write_b128 v20, v[124:127] offset:1024
s_lshl_b32 s67, s60, 14
s_cmp_eq_u32 s60, 7
s_cselect_b32 s67, 147456, s67
v_add_u32 v16, s67, v8
v_lshlrev_b32 v60, 16, v60
v_rcp_f32 v60, v60
s_nop 0
v_mul_f32 v60, v60, v60
s_waitcnt lgkmcnt(0)
s_barrier
ds_read_b128 v[128:131], v16 offset:0
ds_read_b128 v[132:135], v16 offset:1024
ds_read_b128 v[136:139], v16 offset:2048
ds_read_b128 v[140:143], v16 offset:3072
ds_read_b128 v[144:147], v16 offset:4096
ds_read_b128 v[148:151], v16 offset:5120
ds_read_b128 v[152:155], v16 offset:6144
ds_read_b128 v[156:159], v16 offset:7168
ds_read_b128 v[160:163], v16 offset:8192
ds_read_b128 v[164:167], v16 offset:9216
ds_read_b128 v[168:171], v16 offset:10240
ds_read_b128 v[172:175], v16 offset:11264
ds_read_b128 v[176:179], v16 offset:12288
ds_read_b128 v[180:183], v16 offset:13312
ds_read_b128 v[184:187], v16 offset:14336
ds_read_b128 v[188:191], v16 offset:15360
s_waitcnt lgkmcnt(12)
v_pk_add_f32 v[128:129], v[128:129], v[136:137]
v_pk_add_f32 v[130:131], v[130:131], v[138:139]
v_pk_add_f32 v[132:133], v[132:133], v[140:141]
v_pk_add_f32 v[134:135], v[134:135], v[142:143]
s_waitcnt lgkmcnt(10)
v_pk_add_f32 v[128:129], v[128:129], v[144:145]
v_pk_add_f32 v[130:131], v[130:131], v[146:147]
v_pk_add_f32 v[132:133], v[132:133], v[148:149]
v_pk_add_f32 v[134:135], v[134:135], v[150:151]
s_waitcnt lgkmcnt(8)
v_pk_add_f32 v[128:129], v[128:129], v[152:153]
v_pk_add_f32 v[130:131], v[130:131], v[154:155]
v_pk_add_f32 v[132:133], v[132:133], v[156:157]
v_pk_add_f32 v[134:135], v[134:135], v[158:159]
s_waitcnt lgkmcnt(6)
v_pk_add_f32 v[128:129], v[128:129], v[160:161]
v_pk_add_f32 v[130:131], v[130:131], v[162:163]
v_pk_add_f32 v[132:133], v[132:133], v[164:165]
v_pk_add_f32 v[134:135], v[134:135], v[166:167]
s_waitcnt lgkmcnt(4)
v_pk_add_f32 v[128:129], v[128:129], v[168:169]
v_pk_add_f32 v[130:131], v[130:131], v[170:171]
v_pk_add_f32 v[132:133], v[132:133], v[172:173]
v_pk_add_f32 v[134:135], v[134:135], v[174:175]
v_pk_mul_f32 v[128:129], v[60:61], v[128:129] op_sel_hi:[0,1]
v_pk_mul_f32 v[130:131], v[60:61], v[130:131] op_sel_hi:[0,1]
v_pk_mul_f32 v[132:133], v[60:61], v[132:133] op_sel_hi:[0,1]
v_pk_mul_f32 v[134:135], v[60:61], v[134:135] op_sel_hi:[0,1]
s_waitcnt lgkmcnt(0)
v_pk_add_f32 v[176:177], v[176:177], v[184:185]
v_pk_add_f32 v[178:179], v[178:179], v[186:187]
v_pk_add_f32 v[180:181], v[180:181], v[188:189]
v_pk_add_f32 v[182:183], v[182:183], v[190:191]
v_cvt_pk_bf16_f32 v64, v128, v129
v_cvt_pk_bf16_f32 v65, v130, v131
v_cvt_pk_bf16_f32 v66, v132, v133
v_cvt_pk_bf16_f32 v67, v134, v135
v_lshlrev_b32 v128, 16, v64
v_and_b32 v129, 0xffff0000, v64
v_lshlrev_b32 v130, 16, v65
v_and_b32 v131, 0xffff0000, v65
v_lshlrev_b32 v132, 16, v66
v_and_b32 v133, 0xffff0000, v66
v_lshlrev_b32 v134, 16, v67
v_and_b32 v135, 0xffff0000, v67
v_cvt_pk_bf16_f32 v68, v176, v177
v_cvt_pk_bf16_f32 v69, v178, v179
v_cvt_pk_bf16_f32 v70, v180, v181
v_cvt_pk_bf16_f32 v71, v182, v183
v_lshlrev_b32 v176, 16, v68
v_and_b32 v177, 0xffff0000, v68
v_lshlrev_b32 v178, 16, v69
v_and_b32 v179, 0xffff0000, v69
v_lshlrev_b32 v180, 16, v70
v_and_b32 v181, 0xffff0000, v70
v_lshlrev_b32 v182, 16, v71
v_and_b32 v183, 0xffff0000, v71
v_mul_f32 v80, 0xbfb8aa3b, v128
v_mul_f32 v81, 0xbfb8aa3b, v129
v_mul_f32 v82, 0xbfb8aa3b, v130
v_mul_f32 v83, 0xbfb8aa3b, v131
v_mul_f32 v84, 0xbfb8aa3b, v132
v_mul_f32 v85, 0xbfb8aa3b, v133
v_mul_f32 v86, 0xbfb8aa3b, v134
v_mul_f32 v87, 0xbfb8aa3b, v135
v_exp_f32 v80, v80
v_exp_f32 v81, v81
v_exp_f32 v82, v82
v_exp_f32 v83, v83
v_exp_f32 v84, v84
v_exp_f32 v85, v85
v_exp_f32 v86, v86
v_exp_f32 v87, v87
v_add_f32 v80, 1.0, v80
v_add_f32 v81, 1.0, v81
v_add_f32 v82, 1.0, v82
v_add_f32 v83, 1.0, v83
v_add_f32 v84, 1.0, v84
v_add_f32 v85, 1.0, v85
v_add_f32 v86, 1.0, v86
v_add_f32 v87, 1.0, v87
v_rcp_f32 v80, v80
v_rcp_f32 v81, v81
v_rcp_f32 v82, v82
v_rcp_f32 v83, v83
v_rcp_f32 v84, v84
v_rcp_f32 v85, v85
v_rcp_f32 v86, v86
v_rcp_f32 v87, v87
v_mul_f32 v80, v80, v128
v_mul_f32 v81, v81, v129
v_mul_f32 v82, v82, v130
v_mul_f32 v83, v83, v131
v_mul_f32 v84, v84, v132
v_mul_f32 v85, v85, v133
v_mul_f32 v86, v86, v134
v_mul_f32 v87, v87, v135
v_cvt_pk_bf16_f32 v64, v80, v81
v_cvt_pk_bf16_f32 v65, v82, v83
v_cvt_pk_bf16_f32 v66, v84, v85
v_cvt_pk_bf16_f32 v67, v86, v87
v_lshlrev_b32 v80, 16, v64
v_and_b32 v81, 0xffff0000, v64
v_lshlrev_b32 v82, 16, v65
v_and_b32 v83, 0xffff0000, v65
v_lshlrev_b32 v84, 16, v66
v_and_b32 v85, 0xffff0000, v66
v_lshlrev_b32 v86, 16, v67
v_and_b32 v87, 0xffff0000, v67
v_mul_f32 v176, v176, v80
v_mul_f32 v177, v177, v81
v_mul_f32 v178, v178, v82
v_mul_f32 v179, v179, v83
v_mul_f32 v180, v180, v84
v_mul_f32 v181, v181, v85
v_mul_f32 v182, v182, v86
v_mul_f32 v183, v183, v87
v_cvt_pk_bf16_f32 v64, v176, v177
v_cvt_pk_bf16_f32 v65, v178, v179
v_cvt_pk_bf16_f32 v66, v180, v181
v_cvt_pk_bf16_f32 v67, v182, v183
v_lshlrev_b32 v176, 16, v64
v_and_b32 v177, 0xffff0000, v64
v_lshlrev_b32 v178, 16, v65
v_and_b32 v179, 0xffff0000, v65
v_lshlrev_b32 v180, 16, v66
v_and_b32 v181, 0xffff0000, v66
v_lshlrev_b32 v182, 16, v67
v_and_b32 v183, 0xffff0000, v67
v_lshlrev_b32 v128, 16, v56
v_and_b32 v129, 0xffff0000, v56
v_lshlrev_b32 v130, 16, v57
v_and_b32 v131, 0xffff0000, v57
v_lshlrev_b32 v132, 16, v58
v_and_b32 v133, 0xffff0000, v58
v_lshlrev_b32 v134, 16, v59
v_and_b32 v135, 0xffff0000, v59
v_add_f32 v176, v176, v128
v_add_f32 v177, v177, v129
v_add_f32 v178, v178, v130
v_add_f32 v179, v179, v131
v_add_f32 v180, v180, v132
v_add_f32 v181, v181, v133
v_add_f32 v182, v182, v134
v_add_f32 v183, v183, v135
v_cvt_pk_bf16_f32 v64, v176, v177
v_cvt_pk_bf16_f32 v65, v178, v179
v_cvt_pk_bf16_f32 v66, v180, v181
v_cvt_pk_bf16_f32 v67, v182, v183
s_nop 0
v_permlane32_swap_b32 v64, v66
v_permlane32_swap_b32 v65, v67
buffer_store_dwordx4 v[64:67], v23, s[28:31], s71 offen
END:
s_endpgm
CODE_END:
.section .rodata,"a"
.p2align 6
.amdhsa_kernel recurrent_scan__sliding_local_dilated__glu_gated_reglu__prompt_kernel
  .amdhsa_next_free_vgpr 256
  .amdhsa_next_free_sgpr 102
  .amdhsa_accum_offset 256
  .amdhsa_group_segment_fixed_size 0
  .amdhsa_kernarg_size 80
  .amdhsa_user_sgpr_count 2
  .amdhsa_user_sgpr_kernarg_segment_ptr 1
  .amdhsa_system_sgpr_workgroup_id_x 1
.end_amdhsa_kernel
```
